```python
import torch

def _softmax(x, axis=-1):
    return torch.softmax(x, dim=axis)
def _gelu(x):
    return torch.nn.functional.gelu(x, approximate="tanh")
def _silu(x):
    return torch.nn.functional.silu(x)
def _sigmoid(x):
    return torch.sigmoid(x)
def _layernorm(x, axis=-1, eps=1e-5):
    m = x.mean(dim=axis, keepdim=True)
    v = x.var(dim=axis, keepdim=True, unbiased=False)
    return (x - m) / torch.sqrt(v + eps)
def _scatter_add(tgt, idx, src, axis=0):
    return tgt.clone().index_add_(axis, idx, src)
def _segment_sum(src, seg, n):
    out = torch.zeros((n,) + src.shape[1:], dtype=src.dtype)
    return out.index_add_(0, seg, src)
def _pad(x, pw):
    flat = tuple(v for pair in reversed(pw) for v in pair)
    return torch.nn.functional.pad(x, flat)

kernel_name = 'interleave_layers__mha_block__ssm_conv_h3__prompt'

def setup_inputs():

    _w = (lambda a: (lambda t: t.to(torch.bfloat16) if t.is_floating_point() else t)(torch.as_tensor(a)))
    def _A_setup():
        B, S, D, H = 1, 2048, 512, 32
        return {
            "x": _w((lambda *s: torch.randn(*s, dtype=torch.bfloat16) * 0.05)(B, S, D)),
            "wqkv": _w((lambda *s: torch.randn(*s, dtype=torch.bfloat16) * 0.05)(D, 3 * D)),
            "wo": _w((lambda *s: torch.randn(*s, dtype=torch.bfloat16) * 0.05)(D, D)),
        }
    _A_in = _A_setup()

    def _B_setup():
        B, S, D = 1, 2048, 512
        ks = 4
        return {
            "q": _w((lambda *s: torch.randn(*s, dtype=torch.bfloat16) * 0.05)(B, S, D)),
            "k": _w((lambda *s: torch.randn(*s, dtype=torch.bfloat16) * 0.4)(B, S, D)),
            "v": _w((lambda *s: torch.randn(*s, dtype=torch.bfloat16) * 0.4)(B, S, D)),
            "shift_k": _w((lambda *s: torch.randn(*s, dtype=torch.bfloat16) * 0.4)(D, ks) * 0.5),
            "ssm_k": _w((lambda *s: torch.randn(*s, dtype=torch.bfloat16) * 0.4)(D, S) * (1.0 / S ** 0.5)),
            "ssm_D": _w((lambda *s: torch.randn(*s, dtype=torch.bfloat16) * 0.4)(D)),
        }
    _B_in = _B_setup()

    return {
        "A_x": _A_in["x"],
        "A_wqkv": _A_in["wqkv"],
        "A_wo": _A_in["wo"],
        "B_q": _B_in["q"],
        "B_k": _B_in["k"],
        "B_v": _B_in["v"],
        "B_shift_k": _B_in["shift_k"],
        "B_ssm_k": _B_in["ssm_k"],
        "B_ssm_D": _B_in["ssm_D"],
    }

def reference(A_x, A_wqkv, A_wo, B_q, B_k, B_v, B_shift_k, B_ssm_k, B_ssm_D):
    def _A_ref(x, wqkv, wo):
        B, S, D = x.shape
        H = 32
        Dh = D // H
        qkv = (lambda x, *d: x.permute(*d))((x @ wqkv).reshape(B, S, 3, H, Dh), 2, 0, 3, 1, 4)
        q, k, v = qkv[0], qkv[1], qkv[2]
        scores = torch.einsum("bhqd,bhkd->bhqk", q, k) * (Dh ** -0.5)
        p = _softmax(scores, axis=-1)
        o = torch.einsum("bhqk,bhkd->bhqd", p, v)
        return (lambda x, *d: x.permute(*d))(o, 0, 2, 1, 3).reshape(B, S, D) @ wo

    def _B_ref(q, k, v, shift_k, ssm_k, ssm_D):
        B, S, D = q.shape
        ks = shift_k.shape[-1]
        k_pad = _pad(k, ((0, 0), (ks - 1, 0), (0, 0)))
        k_shift = torch.zeros_like(k)
        for t in range(ks):
            k_shift = k_shift + k_pad[:, t:t + S, :] * shift_k[:, ks - 1 - t][None, None, :]
        kv = k_shift * v
        L = 2 * S
        kv_pad = _pad(kv, ((0, 0), (0, S), (0, 0)))
        kf_pad = _pad(ssm_k, ((0, 0), (0, S)))
        kv_f = (lambda x, axes=(-2,-1): torch.fft.rfft2(x.float(), dim=axes))(kv_pad[:, None, :, :], axes=(1, 2))
        kf_f = (lambda x, axes=(-2,-1): torch.fft.rfft2(x.float(), dim=axes))(kf_pad[:, None, :], axes=(1, 2))
        kf_f = (lambda x, *d: x.permute(*d))(kf_f, 1, 2, 0)
        y_f = kv_f * kf_f[None, :, :, :]
        y = (lambda x, s, axes=(-2,-1): torch.fft.irfft2(x, s=s, dim=axes).to(torch.bfloat16))(y_f, (1, L), axes=(1, 2))[:, 0, :S, :]
        y = y + kv * ssm_D[None, None, :]
        return q * y

    x = A_x
    x = x + _A_ref(_layernorm(x, axis=-1), A_wqkv, A_wo)
    x = x + _B_ref(_layernorm(x, axis=-1), B_k, B_v, B_shift_k, B_ssm_k, B_ssm_D)
    x = x + _A_ref(_layernorm(x, axis=-1), A_wqkv, A_wo)
    x = x + _B_ref(_layernorm(x, axis=-1), B_k, B_v, B_shift_k, B_ssm_k, B_ssm_D)
    return x
```

```asm
; @launch kernel=qkv1_kernel grid=(256,1,1) block=(512,1,1) lds=151552
; @launch kernel=mega_kernel grid=(256,1,1) block=(768,1,1) lds=163840
.amdgcn_target "amdgcn-amd-amdhsa--gfx950"
.text
.globl qkv1_kernel
.p2align 8
.type qkv1_kernel,@function
qkv1_kernel:
    s_cmp_ge_u32 s2, 256
    s_cbranch_scc1 qkv1_kernel_done
    s_load_dwordx4 s[4:7], s[0:1], 0
    s_load_dwordx2 s[14:15], s[0:1], 88

    s_load_dwordx4 s[8:11], s[0:1], 32
    s_load_dwordx2 s[12:13], s[0:1], 48

    v_lshrrev_b32 v2, 6, v0
    v_and_b32 v1, 63, v0
    v_readfirstlane_b32 s40, v2
    s_and_b32 s44, s2, 7
    s_lshr_b32 s45, s2, 3

    s_and_b32 s41, s44, 3
    s_lshl_b32 s41, s41, 2
    s_and_b32 s46, s45, 3
    s_add_u32 s41, s41, s46
    s_lshr_b32 s42, s44, 2
    s_lshl_b32 s42, s42, 3
    s_lshr_b32 s46, s45, 2
    s_add_u32 s42, s42, s46

    s_and_b32 s39, s40, 3
    s_lshl_b32 s43, s41, 2
    s_add_u32 s43, s43, s39
    v_lshrrev_b32 v3, 5, v1
    v_and_b32 v4, 31, v1
    v_lshlrev_b32 v9, 4, v1
    s_lshl_b32 s49, s43, 15
    s_cmp_ge_u32 s40, 4
    s_cbranch_scc1 qkv1_kernel_loader
    s_lshl_b32 s50, s40, 11
    s_add_u32 s50, s50, 143360
    s_waitcnt lgkmcnt(0)

    s_mov_b32 s24, s14
    s_mov_b32 s25, s15
    s_mov_b32 s26, 0x2600000
    s_mov_b32 s27, 0x00020000
    s_mov_b32 s16, s4
    s_mov_b32 s17, s5
    s_mov_b32 s18, 0x200000
    s_mov_b32 s19, 0x00020000
    s_mov_b32 s20, s6
    s_mov_b32 s21, s7
    s_mov_b32 s22, 0x180000
    s_mov_b32 s23, 0x00020000
    s_and_b32 s51, s42, 7
    s_cmp_lt_u32 s51, 0
    s_cbranch_scc1 qkv1_kernel_nx
    s_lshl_b32 s51, s51, 7
    s_add_u32 s51, s51, s49
    v_lshlrev_b32 v10, 10, v4
    s_mov_b64 exec, 0xffffffff
    buffer_load_dword v24, v10, s[16:19], s51 offen
    s_mov_b64 exec, -1

qkv1_kernel_nx:
    s_and_b32 s53, s41, 3
    s_lshl_b32 s53, s53, 1
    s_and_b32 s54, s42, 1
    s_add_u32 s53, s53, s54
    s_mul_i32 s53, s53, 3072
    s_lshl_b32 s54, s42, 6
    s_add_u32 s53, s53, s54
    s_add_u32 s53, s53, 0
    s_lshl_b32 s54, s40, 10
    s_add_u32 s53, s53, s54
    s_movk_i32 s54, 24576
    v_mul_lo_u32 v10, v1, s54
    s_cmp_eq_u32 s40, 3
    s_cbranch_scc1 qkv1_kernel_nw
    buffer_load_dword v25, v10, s[20:23], s53 offen

qkv1_kernel_nw:
    s_mov_b32 s67, 0xfffffffe
    s_mov_b32 s55, 0x3f803f80
    v_lshlrev_b32 v21, 9, v3
    v_bfe_u32 v22, v1, 2, 2
    v_lshl_add_u32 v21, v22, 6, v21
    v_bfe_u32 v22, v1, 4, 1
    v_lshl_add_u32 v21, v22, 5, v21
    v_and_b32 v22, 3, v1
    v_lshl_add_u32 v21, v22, 3, v21
    v_add_u32 v22, 57344, v21
    v_add_u32 v23, 114688, v21
    s_lshl_b32 s56, s40, 12
    s_add_u32 s56, s56, 12288

    v_bfe_u32 v13, v1, 1, 3
    v_xor_b32 v13, v13, v3
    v_lshlrev_b32 v13, 4, v13
    v_lshl_add_u32 v13, v4, 7, v13
    v_add_u32 v13, s56, v13

    v_xor_b32 v56, 0, v13
    v_add_u32 v60, 57344, v56
    v_add_u32 v5, 114688, v56
    v_xor_b32 v57, 32, v13
    v_add_u32 v61, 57344, v57
    v_add_u32 v6, 114688, v57
    v_xor_b32 v58, 64, v13
    v_add_u32 v62, 57344, v58
    v_add_u32 v7, 114688, v58
    v_xor_b32 v59, 96, v13
    v_add_u32 v63, 57344, v59
    v_add_u32 v8, 114688, v59
    v_mov_b32 v14, 0
    v_mov_b32 v15, 0
    v_mov_b32 v16, 0
    v_mov_b32 v17, 0
    v_mov_b32 v18, 0
    v_mov_b32 v19, 0
    v_mov_b32 v20, 0
    s_barrier
    ds_read_b128 v[64:67], v56 offset:0
    ds_read_b128 v[68:71], v57 offset:0
    ds_read_b128 v[72:75], v58 offset:0
    ds_read_b128 v[76:79], v59 offset:0
    ds_read_b64_tr_b16 v[144:145], v21 offset:0
    ds_read_b64_tr_b16 v[146:147], v21 offset:256
    ds_read_b64_tr_b16 v[148:149], v21 offset:4096
    ds_read_b64_tr_b16 v[150:151], v21 offset:4352
    ds_read_b64_tr_b16 v[152:153], v21 offset:8192
    ds_read_b64_tr_b16 v[154:155], v21 offset:8448
    s_waitcnt lgkmcnt(0)
    ds_read_b64_tr_b16 v[156:157], v21 offset:1024
    ds_read_b64_tr_b16 v[158:159], v21 offset:1280
    ds_read_b64_tr_b16 v[160:161], v21 offset:5120
    ds_read_b64_tr_b16 v[162:163], v21 offset:5376
    ds_read_b64_tr_b16 v[164:165], v21 offset:9216
    ds_read_b64_tr_b16 v[166:167], v21 offset:9472
    ds_read_b64_tr_b16 v[168:169], v21 offset:2048
    ds_read_b64_tr_b16 v[170:171], v21 offset:2304
    ds_read_b64_tr_b16 v[172:173], v21 offset:6144
    ds_read_b64_tr_b16 v[174:175], v21 offset:6400
    ds_read_b64_tr_b16 v[176:177], v21 offset:10240
    ds_read_b64_tr_b16 v[178:179], v21 offset:10496
    v_mfma_f32_32x32x16_bf16 v[96:111], v[144:147], v[64:67], 0
    v_mfma_f32_32x32x16_bf16 v[112:127], v[148:151], v[64:67], 0
    v_mfma_f32_32x32x16_bf16 v[128:143], v[64:67], v[152:155], 0
    s_cmp_eq_u32 s40, 0
    s_cbranch_scc0 qkv1_kernel_cs_1
    v_dot2c_f32_bf16 v18, s55, v144
    v_dot2c_f32_bf16 v19, s55, v148
    v_dot2c_f32_bf16 v20, s55, v152
    v_dot2c_f32_bf16 v18, s55, v145
    v_dot2c_f32_bf16 v19, s55, v149
    v_dot2c_f32_bf16 v20, s55, v153
    v_dot2c_f32_bf16 v18, s55, v146
    v_dot2c_f32_bf16 v19, s55, v150
    v_dot2c_f32_bf16 v20, s55, v154
    v_dot2c_f32_bf16 v18, s55, v147
    v_dot2c_f32_bf16 v19, s55, v151
    v_dot2c_f32_bf16 v20, s55, v155
qkv1_kernel_cs_1:
    s_waitcnt lgkmcnt(6)
    ds_read_b64_tr_b16 v[144:145], v21 offset:3072
    ds_read_b64_tr_b16 v[146:147], v21 offset:3328
    ds_read_b64_tr_b16 v[148:149], v21 offset:7168
    ds_read_b64_tr_b16 v[150:151], v21 offset:7424
    ds_read_b64_tr_b16 v[152:153], v21 offset:11264
    ds_read_b64_tr_b16 v[154:155], v21 offset:11520
    v_mfma_f32_32x32x16_bf16 v[96:111], v[156:159], v[68:71], v[96:111]
    v_mfma_f32_32x32x16_bf16 v[112:127], v[160:163], v[68:71], v[112:127]
    v_mfma_f32_32x32x16_bf16 v[128:143], v[68:71], v[164:167], v[128:143]
    s_cmp_eq_u32 s40, 1
    s_cbranch_scc0 qkv1_kernel_cs_2
    v_dot2c_f32_bf16 v18, s55, v156
    v_dot2c_f32_bf16 v19, s55, v160
    v_dot2c_f32_bf16 v20, s55, v164
    v_dot2c_f32_bf16 v18, s55, v157
    v_dot2c_f32_bf16 v19, s55, v161
    v_dot2c_f32_bf16 v20, s55, v165
    v_dot2c_f32_bf16 v18, s55, v158
    v_dot2c_f32_bf16 v19, s55, v162
    v_dot2c_f32_bf16 v20, s55, v166
    v_dot2c_f32_bf16 v18, s55, v159
    v_dot2c_f32_bf16 v19, s55, v163
    v_dot2c_f32_bf16 v20, s55, v167
qkv1_kernel_cs_2:
    s_waitcnt lgkmcnt(6)
    v_mfma_f32_32x32x16_bf16 v[96:111], v[168:171], v[72:75], v[96:111]
    v_mfma_f32_32x32x16_bf16 v[112:127], v[172:175], v[72:75], v[112:127]
    v_mfma_f32_32x32x16_bf16 v[128:143], v[72:75], v[176:179], v[128:143]
    s_cmp_eq_u32 s40, 2
    s_cbranch_scc0 qkv1_kernel_cs_3
    v_dot2c_f32_bf16 v18, s55, v168
    v_dot2c_f32_bf16 v19, s55, v172
    v_dot2c_f32_bf16 v20, s55, v176
    v_dot2c_f32_bf16 v18, s55, v169
    v_dot2c_f32_bf16 v19, s55, v173
    v_dot2c_f32_bf16 v20, s55, v177
    v_dot2c_f32_bf16 v18, s55, v170
    v_dot2c_f32_bf16 v19, s55, v174
    v_dot2c_f32_bf16 v20, s55, v178
    v_dot2c_f32_bf16 v18, s55, v171
    v_dot2c_f32_bf16 v19, s55, v175
    v_dot2c_f32_bf16 v20, s55, v179
qkv1_kernel_cs_3:
    v_dot2c_f32_bf16 v14, s55, v64
    v_dot2c_f32_bf16 v16, v64, v64
    v_dot2c_f32_bf16 v15, s55, v65
    v_dot2c_f32_bf16 v17, v65, v65
    v_dot2c_f32_bf16 v14, s55, v66
    v_dot2c_f32_bf16 v16, v66, v66
    v_dot2c_f32_bf16 v15, s55, v67
    v_dot2c_f32_bf16 v17, v67, v67
    v_dot2c_f32_bf16 v14, s55, v68
    v_dot2c_f32_bf16 v16, v68, v68
    v_dot2c_f32_bf16 v15, s55, v69
    v_dot2c_f32_bf16 v17, v69, v69
    v_dot2c_f32_bf16 v14, s55, v70
    v_dot2c_f32_bf16 v16, v70, v70
    v_dot2c_f32_bf16 v15, s55, v71
    v_dot2c_f32_bf16 v17, v71, v71
    v_dot2c_f32_bf16 v14, s55, v72
    v_dot2c_f32_bf16 v16, v72, v72
    v_dot2c_f32_bf16 v15, s55, v73
    v_dot2c_f32_bf16 v17, v73, v73
    v_dot2c_f32_bf16 v14, s55, v74
    v_dot2c_f32_bf16 v16, v74, v74
    v_dot2c_f32_bf16 v15, s55, v75
    v_dot2c_f32_bf16 v17, v75, v75
    v_dot2c_f32_bf16 v14, s55, v76
    v_dot2c_f32_bf16 v16, v76, v76
    v_dot2c_f32_bf16 v15, s55, v77
    v_dot2c_f32_bf16 v17, v77, v77
    v_dot2c_f32_bf16 v14, s55, v78
    v_dot2c_f32_bf16 v16, v78, v78
    v_dot2c_f32_bf16 v15, s55, v79
    v_dot2c_f32_bf16 v17, v79, v79
    s_waitcnt lgkmcnt(0)
    s_barrier
    ds_read_b128 v[80:83], v56 offset:28672
    ds_read_b128 v[84:87], v57 offset:28672
    ds_read_b128 v[88:91], v58 offset:28672
    ds_read_b128 v[92:95], v59 offset:28672
    ds_read_b64_tr_b16 v[156:157], v21 offset:28672
    ds_read_b64_tr_b16 v[158:159], v21 offset:28928
    ds_read_b64_tr_b16 v[160:161], v21 offset:32768
    ds_read_b64_tr_b16 v[162:163], v21 offset:33024
    ds_read_b64_tr_b16 v[164:165], v21 offset:36864
    ds_read_b64_tr_b16 v[166:167], v21 offset:37120
    v_mfma_f32_32x32x16_bf16 v[96:111], v[144:147], v[76:79], v[96:111]
    v_mfma_f32_32x32x16_bf16 v[112:127], v[148:151], v[76:79], v[112:127]
    v_mfma_f32_32x32x16_bf16 v[128:143], v[76:79], v[152:155], v[128:143]
    s_cmp_eq_u32 s40, 3
    s_cbranch_scc0 qkv1_kernel_cs_4
    v_dot2c_f32_bf16 v18, s55, v144
    v_dot2c_f32_bf16 v19, s55, v148
    v_dot2c_f32_bf16 v20, s55, v152
    v_dot2c_f32_bf16 v18, s55, v145
    v_dot2c_f32_bf16 v19, s55, v149
    v_dot2c_f32_bf16 v20, s55, v153
    v_dot2c_f32_bf16 v18, s55, v146
    v_dot2c_f32_bf16 v19, s55, v150
    v_dot2c_f32_bf16 v20, s55, v154
    v_dot2c_f32_bf16 v18, s55, v147
    v_dot2c_f32_bf16 v19, s55, v151
    v_dot2c_f32_bf16 v20, s55, v155
qkv1_kernel_cs_4:
    s_waitcnt lgkmcnt(0)
    ds_read_b64_tr_b16 v[168:169], v21 offset:29696
    ds_read_b64_tr_b16 v[170:171], v21 offset:29952
    ds_read_b64_tr_b16 v[172:173], v21 offset:33792
    ds_read_b64_tr_b16 v[174:175], v21 offset:34048
    ds_read_b64_tr_b16 v[176:177], v21 offset:37888
    ds_read_b64_tr_b16 v[178:179], v21 offset:38144
    ds_read_b64_tr_b16 v[144:145], v21 offset:30720
    ds_read_b64_tr_b16 v[146:147], v21 offset:30976
    ds_read_b64_tr_b16 v[148:149], v21 offset:34816
    ds_read_b64_tr_b16 v[150:151], v21 offset:35072
    ds_read_b64_tr_b16 v[152:153], v21 offset:38912
    ds_read_b64_tr_b16 v[154:155], v21 offset:39168
    v_mfma_f32_32x32x16_bf16 v[96:111], v[156:159], v[80:83], v[96:111]
    v_mfma_f32_32x32x16_bf16 v[112:127], v[160:163], v[80:83], v[112:127]
    v_mfma_f32_32x32x16_bf16 v[128:143], v[80:83], v[164:167], v[128:143]
    s_cmp_eq_u32 s40, 0
    s_cbranch_scc0 qkv1_kernel_cs_5
    v_dot2c_f32_bf16 v18, s55, v156
    v_dot2c_f32_bf16 v19, s55, v160
    v_dot2c_f32_bf16 v20, s55, v164
    v_dot2c_f32_bf16 v18, s55, v157
    v_dot2c_f32_bf16 v19, s55, v161
    v_dot2c_f32_bf16 v20, s55, v165
    v_dot2c_f32_bf16 v18, s55, v158
    v_dot2c_f32_bf16 v19, s55, v162
    v_dot2c_f32_bf16 v20, s55, v166
    v_dot2c_f32_bf16 v18, s55, v159
    v_dot2c_f32_bf16 v19, s55, v163
    v_dot2c_f32_bf16 v20, s55, v167
qkv1_kernel_cs_5:
    s_waitcnt lgkmcnt(6)
    ds_read_b64_tr_b16 v[156:157], v21 offset:31744
    ds_read_b64_tr_b16 v[158:159], v21 offset:32000
    ds_read_b64_tr_b16 v[160:161], v21 offset:35840
    ds_read_b64_tr_b16 v[162:163], v21 offset:36096
    ds_read_b64_tr_b16 v[164:165], v21 offset:39936
    ds_read_b64_tr_b16 v[166:167], v21 offset:40192
    v_mfma_f32_32x32x16_bf16 v[96:111], v[168:171], v[84:87], v[96:111]
    v_mfma_f32_32x32x16_bf16 v[112:127], v[172:175], v[84:87], v[112:127]
    v_mfma_f32_32x32x16_bf16 v[128:143], v[84:87], v[176:179], v[128:143]
    s_cmp_eq_u32 s40, 1
    s_cbranch_scc0 qkv1_kernel_cs_6
    v_dot2c_f32_bf16 v18, s55, v168
    v_dot2c_f32_bf16 v19, s55, v172
    v_dot2c_f32_bf16 v20, s55, v176
    v_dot2c_f32_bf16 v18, s55, v169
    v_dot2c_f32_bf16 v19, s55, v173
    v_dot2c_f32_bf16 v20, s55, v177
    v_dot2c_f32_bf16 v18, s55, v170
    v_dot2c_f32_bf16 v19, s55, v174
    v_dot2c_f32_bf16 v20, s55, v178
    v_dot2c_f32_bf16 v18, s55, v171
    v_dot2c_f32_bf16 v19, s55, v175
    v_dot2c_f32_bf16 v20, s55, v179
qkv1_kernel_cs_6:
    s_waitcnt lgkmcnt(6)
    v_mfma_f32_32x32x16_bf16 v[96:111], v[144:147], v[88:91], v[96:111]
    v_mfma_f32_32x32x16_bf16 v[112:127], v[148:151], v[88:91], v[112:127]
    v_mfma_f32_32x32x16_bf16 v[128:143], v[88:91], v[152:155], v[128:143]
    s_cmp_eq_u32 s40, 2
    s_cbranch_scc0 qkv1_kernel_cs_7
    v_dot2c_f32_bf16 v18, s55, v144
    v_dot2c_f32_bf16 v19, s55, v148
    v_dot2c_f32_bf16 v20, s55, v152
    v_dot2c_f32_bf16 v18, s55, v145
    v_dot2c_f32_bf16 v19, s55, v149
    v_dot2c_f32_bf16 v20, s55, v153
    v_dot2c_f32_bf16 v18, s55, v146
    v_dot2c_f32_bf16 v19, s55, v150
    v_dot2c_f32_bf16 v20, s55, v154
    v_dot2c_f32_bf16 v18, s55, v147
    v_dot2c_f32_bf16 v19, s55, v151
    v_dot2c_f32_bf16 v20, s55, v155
qkv1_kernel_cs_7:
    v_dot2c_f32_bf16 v14, s55, v80
    v_dot2c_f32_bf16 v16, v80, v80
    v_dot2c_f32_bf16 v15, s55, v81
    v_dot2c_f32_bf16 v17, v81, v81
    v_dot2c_f32_bf16 v14, s55, v82
    v_dot2c_f32_bf16 v16, v82, v82
    v_dot2c_f32_bf16 v15, s55, v83
    v_dot2c_f32_bf16 v17, v83, v83
    v_dot2c_f32_bf16 v14, s55, v84
    v_dot2c_f32_bf16 v16, v84, v84
    v_dot2c_f32_bf16 v15, s55, v85
    v_dot2c_f32_bf16 v17, v85, v85
    v_dot2c_f32_bf16 v14, s55, v86
    v_dot2c_f32_bf16 v16, v86, v86
    v_dot2c_f32_bf16 v15, s55, v87
    v_dot2c_f32_bf16 v17, v87, v87
    v_dot2c_f32_bf16 v14, s55, v88
    v_dot2c_f32_bf16 v16, v88, v88
    v_dot2c_f32_bf16 v15, s55, v89
    v_dot2c_f32_bf16 v17, v89, v89
    v_dot2c_f32_bf16 v14, s55, v90
    v_dot2c_f32_bf16 v16, v90, v90
    v_dot2c_f32_bf16 v15, s55, v91
    v_dot2c_f32_bf16 v17, v91, v91
    v_dot2c_f32_bf16 v14, s55, v92
    v_dot2c_f32_bf16 v16, v92, v92
    v_dot2c_f32_bf16 v15, s55, v93
    v_dot2c_f32_bf16 v17, v93, v93
    v_dot2c_f32_bf16 v14, s55, v94
    v_dot2c_f32_bf16 v16, v94, v94
    v_dot2c_f32_bf16 v15, s55, v95
    v_dot2c_f32_bf16 v17, v95, v95
    s_waitcnt lgkmcnt(0)
    s_barrier
    ds_read_b128 v[64:67], v60 offset:0
    ds_read_b128 v[68:71], v61 offset:0
    ds_read_b128 v[72:75], v62 offset:0
    ds_read_b128 v[76:79], v63 offset:0
    ds_read_b64_tr_b16 v[168:169], v22 offset:0
    ds_read_b64_tr_b16 v[170:171], v22 offset:256
    ds_read_b64_tr_b16 v[172:173], v22 offset:4096
    ds_read_b64_tr_b16 v[174:175], v22 offset:4352
    ds_read_b64_tr_b16 v[176:177], v22 offset:8192
    ds_read_b64_tr_b16 v[178:179], v22 offset:8448
    v_mfma_f32_32x32x16_bf16 v[96:111], v[156:159], v[92:95], v[96:111]
    v_mfma_f32_32x32x16_bf16 v[112:127], v[160:163], v[92:95], v[112:127]
    v_mfma_f32_32x32x16_bf16 v[128:143], v[92:95], v[164:167], v[128:143]
    s_cmp_eq_u32 s40, 3
    s_cbranch_scc0 qkv1_kernel_cs_8
    v_dot2c_f32_bf16 v18, s55, v156
    v_dot2c_f32_bf16 v19, s55, v160
    v_dot2c_f32_bf16 v20, s55, v164
    v_dot2c_f32_bf16 v18, s55, v157
    v_dot2c_f32_bf16 v19, s55, v161
    v_dot2c_f32_bf16 v20, s55, v165
    v_dot2c_f32_bf16 v18, s55, v158
    v_dot2c_f32_bf16 v19, s55, v162
    v_dot2c_f32_bf16 v20, s55, v166
    v_dot2c_f32_bf16 v18, s55, v159
    v_dot2c_f32_bf16 v19, s55, v163
    v_dot2c_f32_bf16 v20, s55, v167
qkv1_kernel_cs_8:
    s_waitcnt lgkmcnt(0)
    ds_read_b64_tr_b16 v[144:145], v22 offset:1024
    ds_read_b64_tr_b16 v[146:147], v22 offset:1280
    ds_read_b64_tr_b16 v[148:149], v22 offset:5120
    ds_read_b64_tr_b16 v[150:151], v22 offset:5376
    ds_read_b64_tr_b16 v[152:153], v22 offset:9216
    ds_read_b64_tr_b16 v[154:155], v22 offset:9472
    ds_read_b64_tr_b16 v[156:157], v22 offset:2048
    ds_read_b64_tr_b16 v[158:159], v22 offset:2304
    ds_read_b64_tr_b16 v[160:161], v22 offset:6144
    ds_read_b64_tr_b16 v[162:163], v22 offset:6400
    ds_read_b64_tr_b16 v[164:165], v22 offset:10240
    ds_read_b64_tr_b16 v[166:167], v22 offset:10496
    v_mfma_f32_32x32x16_bf16 v[96:111], v[168:171], v[64:67], v[96:111]
    v_mfma_f32_32x32x16_bf16 v[112:127], v[172:175], v[64:67], v[112:127]
    v_mfma_f32_32x32x16_bf16 v[128:143], v[64:67], v[176:179], v[128:143]
    s_cmp_eq_u32 s40, 0
    s_cbranch_scc0 qkv1_kernel_cs_9
    v_dot2c_f32_bf16 v18, s55, v168
    v_dot2c_f32_bf16 v19, s55, v172
    v_dot2c_f32_bf16 v20, s55, v176
    v_dot2c_f32_bf16 v18, s55, v169
    v_dot2c_f32_bf16 v19, s55, v173
    v_dot2c_f32_bf16 v20, s55, v177
    v_dot2c_f32_bf16 v18, s55, v170
    v_dot2c_f32_bf16 v19, s55, v174
    v_dot2c_f32_bf16 v20, s55, v178
    v_dot2c_f32_bf16 v18, s55, v171
    v_dot2c_f32_bf16 v19, s55, v175
    v_dot2c_f32_bf16 v20, s55, v179
qkv1_kernel_cs_9:
    s_waitcnt lgkmcnt(6)
    ds_read_b64_tr_b16 v[168:169], v22 offset:3072
    ds_read_b64_tr_b16 v[170:171], v22 offset:3328
    ds_read_b64_tr_b16 v[172:173], v22 offset:7168
    ds_read_b64_tr_b16 v[174:175], v22 offset:7424
    ds_read_b64_tr_b16 v[176:177], v22 offset:11264
    ds_read_b64_tr_b16 v[178:179], v22 offset:11520
    v_mfma_f32_32x32x16_bf16 v[96:111], v[144:147], v[68:71], v[96:111]
    v_mfma_f32_32x32x16_bf16 v[112:127], v[148:151], v[68:71], v[112:127]
    v_mfma_f32_32x32x16_bf16 v[128:143], v[68:71], v[152:155], v[128:143]
    s_cmp_eq_u32 s40, 1
    s_cbranch_scc0 qkv1_kernel_cs_10
    v_dot2c_f32_bf16 v18, s55, v144
    v_dot2c_f32_bf16 v19, s55, v148
    v_dot2c_f32_bf16 v20, s55, v152
    v_dot2c_f32_bf16 v18, s55, v145
    v_dot2c_f32_bf16 v19, s55, v149
    v_dot2c_f32_bf16 v20, s55, v153
    v_dot2c_f32_bf16 v18, s55, v146
    v_dot2c_f32_bf16 v19, s55, v150
    v_dot2c_f32_bf16 v20, s55, v154
    v_dot2c_f32_bf16 v18, s55, v147
    v_dot2c_f32_bf16 v19, s55, v151
    v_dot2c_f32_bf16 v20, s55, v155
qkv1_kernel_cs_10:
    s_waitcnt lgkmcnt(6)
    v_mfma_f32_32x32x16_bf16 v[96:111], v[156:159], v[72:75], v[96:111]
    v_mfma_f32_32x32x16_bf16 v[112:127], v[160:163], v[72:75], v[112:127]
    v_mfma_f32_32x32x16_bf16 v[128:143], v[72:75], v[164:167], v[128:143]
    s_cmp_eq_u32 s40, 2
    s_cbranch_scc0 qkv1_kernel_cs_11
    v_dot2c_f32_bf16 v18, s55, v156
    v_dot2c_f32_bf16 v19, s55, v160
    v_dot2c_f32_bf16 v20, s55, v164
    v_dot2c_f32_bf16 v18, s55, v157
    v_dot2c_f32_bf16 v19, s55, v161
    v_dot2c_f32_bf16 v20, s55, v165
    v_dot2c_f32_bf16 v18, s55, v158
    v_dot2c_f32_bf16 v19, s55, v162
    v_dot2c_f32_bf16 v20, s55, v166
    v_dot2c_f32_bf16 v18, s55, v159
    v_dot2c_f32_bf16 v19, s55, v163
    v_dot2c_f32_bf16 v20, s55, v167
qkv1_kernel_cs_11:
    v_dot2c_f32_bf16 v14, s55, v64
    v_dot2c_f32_bf16 v16, v64, v64
    v_dot2c_f32_bf16 v15, s55, v65
    v_dot2c_f32_bf16 v17, v65, v65
    v_dot2c_f32_bf16 v14, s55, v66
    v_dot2c_f32_bf16 v16, v66, v66
    v_dot2c_f32_bf16 v15, s55, v67
    v_dot2c_f32_bf16 v17, v67, v67
    v_dot2c_f32_bf16 v14, s55, v68
    v_dot2c_f32_bf16 v16, v68, v68
    v_dot2c_f32_bf16 v15, s55, v69
    v_dot2c_f32_bf16 v17, v69, v69
    v_dot2c_f32_bf16 v14, s55, v70
    v_dot2c_f32_bf16 v16, v70, v70
    v_dot2c_f32_bf16 v15, s55, v71
    v_dot2c_f32_bf16 v17, v71, v71
    v_dot2c_f32_bf16 v14, s55, v72
    v_dot2c_f32_bf16 v16, v72, v72
    v_dot2c_f32_bf16 v15, s55, v73
    v_dot2c_f32_bf16 v17, v73, v73
    v_dot2c_f32_bf16 v14, s55, v74
    v_dot2c_f32_bf16 v16, v74, v74
    v_dot2c_f32_bf16 v15, s55, v75
    v_dot2c_f32_bf16 v17, v75, v75
    v_dot2c_f32_bf16 v14, s55, v76
    v_dot2c_f32_bf16 v16, v76, v76
    v_dot2c_f32_bf16 v15, s55, v77
    v_dot2c_f32_bf16 v17, v77, v77
    v_dot2c_f32_bf16 v14, s55, v78
    v_dot2c_f32_bf16 v16, v78, v78
    v_dot2c_f32_bf16 v15, s55, v79
    v_dot2c_f32_bf16 v17, v79, v79
    s_waitcnt lgkmcnt(0)
    s_barrier
    ds_read_b128 v[80:83], v60 offset:28672
    ds_read_b128 v[84:87], v61 offset:28672
    ds_read_b128 v[88:91], v62 offset:28672
    ds_read_b128 v[92:95], v63 offset:28672
    ds_read_b64_tr_b16 v[144:145], v22 offset:28672
    ds_read_b64_tr_b16 v[146:147], v22 offset:28928
    ds_read_b64_tr_b16 v[148:149], v22 offset:32768
    ds_read_b64_tr_b16 v[150:151], v22 offset:33024
    ds_read_b64_tr_b16 v[152:153], v22 offset:36864
    ds_read_b64_tr_b16 v[154:155], v22 offset:37120
    v_mfma_f32_32x32x16_bf16 v[96:111], v[168:171], v[76:79], v[96:111]
    v_mfma_f32_32x32x16_bf16 v[112:127], v[172:175], v[76:79], v[112:127]
    v_mfma_f32_32x32x16_bf16 v[128:143], v[76:79], v[176:179], v[128:143]
    s_cmp_eq_u32 s40, 3
    s_cbranch_scc0 qkv1_kernel_cs_12
    v_dot2c_f32_bf16 v18, s55, v168
    v_dot2c_f32_bf16 v19, s55, v172
    v_dot2c_f32_bf16 v20, s55, v176
    v_dot2c_f32_bf16 v18, s55, v169
    v_dot2c_f32_bf16 v19, s55, v173
    v_dot2c_f32_bf16 v20, s55, v177
    v_dot2c_f32_bf16 v18, s55, v170
    v_dot2c_f32_bf16 v19, s55, v174
    v_dot2c_f32_bf16 v20, s55, v178
    v_dot2c_f32_bf16 v18, s55, v171
    v_dot2c_f32_bf16 v19, s55, v175
    v_dot2c_f32_bf16 v20, s55, v179
qkv1_kernel_cs_12:
    s_waitcnt lgkmcnt(0)
    ds_read_b64_tr_b16 v[156:157], v22 offset:29696
    ds_read_b64_tr_b16 v[158:159], v22 offset:29952
    ds_read_b64_tr_b16 v[160:161], v22 offset:33792
    ds_read_b64_tr_b16 v[162:163], v22 offset:34048
    ds_read_b64_tr_b16 v[164:165], v22 offset:37888
    ds_read_b64_tr_b16 v[166:167], v22 offset:38144
    ds_read_b64_tr_b16 v[168:169], v22 offset:30720
    ds_read_b64_tr_b16 v[170:171], v22 offset:30976
    ds_read_b64_tr_b16 v[172:173], v22 offset:34816
    ds_read_b64_tr_b16 v[174:175], v22 offset:35072
    ds_read_b64_tr_b16 v[176:177], v22 offset:38912
    ds_read_b64_tr_b16 v[178:179], v22 offset:39168
    v_mfma_f32_32x32x16_bf16 v[96:111], v[144:147], v[80:83], v[96:111]
    v_mfma_f32_32x32x16_bf16 v[112:127], v[148:151], v[80:83], v[112:127]
    v_mfma_f32_32x32x16_bf16 v[128:143], v[80:83], v[152:155], v[128:143]
    s_cmp_eq_u32 s40, 0
    s_cbranch_scc0 qkv1_kernel_cs_13
    v_dot2c_f32_bf16 v18, s55, v144
    v_dot2c_f32_bf16 v19, s55, v148
    v_dot2c_f32_bf16 v20, s55, v152
    v_dot2c_f32_bf16 v18, s55, v145
    v_dot2c_f32_bf16 v19, s55, v149
    v_dot2c_f32_bf16 v20, s55, v153
    v_dot2c_f32_bf16 v18, s55, v146
    v_dot2c_f32_bf16 v19, s55, v150
    v_dot2c_f32_bf16 v20, s55, v154
    v_dot2c_f32_bf16 v18, s55, v147
    v_dot2c_f32_bf16 v19, s55, v151
    v_dot2c_f32_bf16 v20, s55, v155
qkv1_kernel_cs_13:
    s_waitcnt lgkmcnt(6)
    ds_read_b64_tr_b16 v[144:145], v22 offset:31744
    ds_read_b64_tr_b16 v[146:147], v22 offset:32000
    ds_read_b64_tr_b16 v[148:149], v22 offset:35840
    ds_read_b64_tr_b16 v[150:151], v22 offset:36096
    ds_read_b64_tr_b16 v[152:153], v22 offset:39936
    ds_read_b64_tr_b16 v[154:155], v22 offset:40192
    v_mfma_f32_32x32x16_bf16 v[96:111], v[156:159], v[84:87], v[96:111]
    v_mfma_f32_32x32x16_bf16 v[112:127], v[160:163], v[84:87], v[112:127]
    v_mfma_f32_32x32x16_bf16 v[128:143], v[84:87], v[164:167], v[128:143]
    s_cmp_eq_u32 s40, 1
    s_cbranch_scc0 qkv1_kernel_cs_14
    v_dot2c_f32_bf16 v18, s55, v156
    v_dot2c_f32_bf16 v19, s55, v160
    v_dot2c_f32_bf16 v20, s55, v164
    v_dot2c_f32_bf16 v18, s55, v157
    v_dot2c_f32_bf16 v19, s55, v161
    v_dot2c_f32_bf16 v20, s55, v165
    v_dot2c_f32_bf16 v18, s55, v158
    v_dot2c_f32_bf16 v19, s55, v162
    v_dot2c_f32_bf16 v20, s55, v166
    v_dot2c_f32_bf16 v18, s55, v159
    v_dot2c_f32_bf16 v19, s55, v163
    v_dot2c_f32_bf16 v20, s55, v167
qkv1_kernel_cs_14:
    s_waitcnt lgkmcnt(6)
    v_mfma_f32_32x32x16_bf16 v[96:111], v[168:171], v[88:91], v[96:111]
    v_mfma_f32_32x32x16_bf16 v[112:127], v[172:175], v[88:91], v[112:127]
    v_mfma_f32_32x32x16_bf16 v[128:143], v[88:91], v[176:179], v[128:143]
    s_cmp_eq_u32 s40, 2
    s_cbranch_scc0 qkv1_kernel_cs_15
    v_dot2c_f32_bf16 v18, s55, v168
    v_dot2c_f32_bf16 v19, s55, v172
    v_dot2c_f32_bf16 v20, s55, v176
    v_dot2c_f32_bf16 v18, s55, v169
    v_dot2c_f32_bf16 v19, s55, v173
    v_dot2c_f32_bf16 v20, s55, v177
    v_dot2c_f32_bf16 v18, s55, v170
    v_dot2c_f32_bf16 v19, s55, v174
    v_dot2c_f32_bf16 v20, s55, v178
    v_dot2c_f32_bf16 v18, s55, v171
    v_dot2c_f32_bf16 v19, s55, v175
    v_dot2c_f32_bf16 v20, s55, v179
qkv1_kernel_cs_15:
    v_dot2c_f32_bf16 v14, s55, v80
    v_dot2c_f32_bf16 v16, v80, v80
    v_dot2c_f32_bf16 v15, s55, v81
    v_dot2c_f32_bf16 v17, v81, v81
    v_dot2c_f32_bf16 v14, s55, v82
    v_dot2c_f32_bf16 v16, v82, v82
    v_dot2c_f32_bf16 v15, s55, v83
    v_dot2c_f32_bf16 v17, v83, v83
    v_dot2c_f32_bf16 v14, s55, v84
    v_dot2c_f32_bf16 v16, v84, v84
    v_dot2c_f32_bf16 v15, s55, v85
    v_dot2c_f32_bf16 v17, v85, v85
    v_dot2c_f32_bf16 v14, s55, v86
    v_dot2c_f32_bf16 v16, v86, v86
    v_dot2c_f32_bf16 v15, s55, v87
    v_dot2c_f32_bf16 v17, v87, v87
    v_dot2c_f32_bf16 v14, s55, v88
    v_dot2c_f32_bf16 v16, v88, v88
    v_dot2c_f32_bf16 v15, s55, v89
    v_dot2c_f32_bf16 v17, v89, v89
    v_dot2c_f32_bf16 v14, s55, v90
    v_dot2c_f32_bf16 v16, v90, v90
    v_dot2c_f32_bf16 v15, s55, v91
    v_dot2c_f32_bf16 v17, v91, v91
    v_dot2c_f32_bf16 v14, s55, v92
    v_dot2c_f32_bf16 v16, v92, v92
    v_dot2c_f32_bf16 v15, s55, v93
    v_dot2c_f32_bf16 v17, v93, v93
    v_dot2c_f32_bf16 v14, s55, v94
    v_dot2c_f32_bf16 v16, v94, v94
    v_dot2c_f32_bf16 v15, s55, v95
    v_dot2c_f32_bf16 v17, v95, v95
    s_waitcnt lgkmcnt(0)
    s_barrier
    ds_read_b128 v[64:67], v5 offset:0
    ds_read_b128 v[68:71], v6 offset:0
    ds_read_b128 v[72:75], v7 offset:0
    ds_read_b128 v[76:79], v8 offset:0
    ds_read_b64_tr_b16 v[156:157], v23 offset:0
    ds_read_b64_tr_b16 v[158:159], v23 offset:256
    ds_read_b64_tr_b16 v[160:161], v23 offset:4096
    ds_read_b64_tr_b16 v[162:163], v23 offset:4352
    ds_read_b64_tr_b16 v[164:165], v23 offset:8192
    ds_read_b64_tr_b16 v[166:167], v23 offset:8448
    v_mfma_f32_32x32x16_bf16 v[96:111], v[144:147], v[92:95], v[96:111]
    v_mfma_f32_32x32x16_bf16 v[112:127], v[148:151], v[92:95], v[112:127]
    v_mfma_f32_32x32x16_bf16 v[128:143], v[92:95], v[152:155], v[128:143]
    s_cmp_eq_u32 s40, 3
    s_cbranch_scc0 qkv1_kernel_cs_16
    v_dot2c_f32_bf16 v18, s55, v144
    v_dot2c_f32_bf16 v19, s55, v148
    v_dot2c_f32_bf16 v20, s55, v152
    v_dot2c_f32_bf16 v18, s55, v145
    v_dot2c_f32_bf16 v19, s55, v149
    v_dot2c_f32_bf16 v20, s55, v153
    v_dot2c_f32_bf16 v18, s55, v146
    v_dot2c_f32_bf16 v19, s55, v150
    v_dot2c_f32_bf16 v20, s55, v154
    v_dot2c_f32_bf16 v18, s55, v147
    v_dot2c_f32_bf16 v19, s55, v151
    v_dot2c_f32_bf16 v20, s55, v155
qkv1_kernel_cs_16:
    s_waitcnt lgkmcnt(0)
    ds_read_b64_tr_b16 v[168:169], v23 offset:1024
    ds_read_b64_tr_b16 v[170:171], v23 offset:1280
    ds_read_b64_tr_b16 v[172:173], v23 offset:5120
    ds_read_b64_tr_b16 v[174:175], v23 offset:5376
    ds_read_b64_tr_b16 v[176:177], v23 offset:9216
    ds_read_b64_tr_b16 v[178:179], v23 offset:9472
    ds_read_b64_tr_b16 v[144:145], v23 offset:2048
    ds_read_b64_tr_b16 v[146:147], v23 offset:2304
    ds_read_b64_tr_b16 v[148:149], v23 offset:6144
    ds_read_b64_tr_b16 v[150:151], v23 offset:6400
    ds_read_b64_tr_b16 v[152:153], v23 offset:10240
    ds_read_b64_tr_b16 v[154:155], v23 offset:10496
    v_mfma_f32_32x32x16_bf16 v[96:111], v[156:159], v[64:67], v[96:111]
    v_mfma_f32_32x32x16_bf16 v[112:127], v[160:163], v[64:67], v[112:127]
    v_mfma_f32_32x32x16_bf16 v[128:143], v[64:67], v[164:167], v[128:143]
    s_cmp_eq_u32 s40, 0
    s_cbranch_scc0 qkv1_kernel_cs_17
    v_dot2c_f32_bf16 v18, s55, v156
    v_dot2c_f32_bf16 v19, s55, v160
    v_dot2c_f32_bf16 v20, s55, v164
    v_dot2c_f32_bf16 v18, s55, v157
    v_dot2c_f32_bf16 v19, s55, v161
    v_dot2c_f32_bf16 v20, s55, v165
    v_dot2c_f32_bf16 v18, s55, v158
    v_dot2c_f32_bf16 v19, s55, v162
    v_dot2c_f32_bf16 v20, s55, v166
    v_dot2c_f32_bf16 v18, s55, v159
    v_dot2c_f32_bf16 v19, s55, v163
    v_dot2c_f32_bf16 v20, s55, v167
qkv1_kernel_cs_17:
    s_waitcnt lgkmcnt(6)
    ds_read_b64_tr_b16 v[156:157], v23 offset:3072
    ds_read_b64_tr_b16 v[158:159], v23 offset:3328
    ds_read_b64_tr_b16 v[160:161], v23 offset:7168
    ds_read_b64_tr_b16 v[162:163], v23 offset:7424
    ds_read_b64_tr_b16 v[164:165], v23 offset:11264
    ds_read_b64_tr_b16 v[166:167], v23 offset:11520
    v_mfma_f32_32x32x16_bf16 v[96:111], v[168:171], v[68:71], v[96:111]
    v_mfma_f32_32x32x16_bf16 v[112:127], v[172:175], v[68:71], v[112:127]
    v_mfma_f32_32x32x16_bf16 v[128:143], v[68:71], v[176:179], v[128:143]
    s_cmp_eq_u32 s40, 1
    s_cbranch_scc0 qkv1_kernel_cs_18
    v_dot2c_f32_bf16 v18, s55, v168
    v_dot2c_f32_bf16 v19, s55, v172
    v_dot2c_f32_bf16 v20, s55, v176
    v_dot2c_f32_bf16 v18, s55, v169
    v_dot2c_f32_bf16 v19, s55, v173
    v_dot2c_f32_bf16 v20, s55, v177
    v_dot2c_f32_bf16 v18, s55, v170
    v_dot2c_f32_bf16 v19, s55, v174
    v_dot2c_f32_bf16 v20, s55, v178
    v_dot2c_f32_bf16 v18, s55, v171
    v_dot2c_f32_bf16 v19, s55, v175
    v_dot2c_f32_bf16 v20, s55, v179
qkv1_kernel_cs_18:
    s_waitcnt lgkmcnt(6)
    v_mfma_f32_32x32x16_bf16 v[96:111], v[144:147], v[72:75], v[96:111]
    v_mfma_f32_32x32x16_bf16 v[112:127], v[148:151], v[72:75], v[112:127]
    v_mfma_f32_32x32x16_bf16 v[128:143], v[72:75], v[152:155], v[128:143]
    s_cmp_eq_u32 s40, 2
    s_cbranch_scc0 qkv1_kernel_cs_19
    v_dot2c_f32_bf16 v18, s55, v144
    v_dot2c_f32_bf16 v19, s55, v148
    v_dot2c_f32_bf16 v20, s55, v152
    v_dot2c_f32_bf16 v18, s55, v145
    v_dot2c_f32_bf16 v19, s55, v149
    v_dot2c_f32_bf16 v20, s55, v153
    v_dot2c_f32_bf16 v18, s55, v146
    v_dot2c_f32_bf16 v19, s55, v150
    v_dot2c_f32_bf16 v20, s55, v154
    v_dot2c_f32_bf16 v18, s55, v147
    v_dot2c_f32_bf16 v19, s55, v151
    v_dot2c_f32_bf16 v20, s55, v155
qkv1_kernel_cs_19:
    v_dot2c_f32_bf16 v14, s55, v64
    v_dot2c_f32_bf16 v16, v64, v64
    v_dot2c_f32_bf16 v15, s55, v65
    v_dot2c_f32_bf16 v17, v65, v65
    v_dot2c_f32_bf16 v14, s55, v66
    v_dot2c_f32_bf16 v16, v66, v66
    v_dot2c_f32_bf16 v15, s55, v67
    v_dot2c_f32_bf16 v17, v67, v67
    v_dot2c_f32_bf16 v14, s55, v68
    v_dot2c_f32_bf16 v16, v68, v68
    v_dot2c_f32_bf16 v15, s55, v69
    v_dot2c_f32_bf16 v17, v69, v69
    v_dot2c_f32_bf16 v14, s55, v70
    v_dot2c_f32_bf16 v16, v70, v70
    v_dot2c_f32_bf16 v15, s55, v71
    v_dot2c_f32_bf16 v17, v71, v71
    v_dot2c_f32_bf16 v14, s55, v72
    v_dot2c_f32_bf16 v16, v72, v72
    v_dot2c_f32_bf16 v15, s55, v73
    v_dot2c_f32_bf16 v17, v73, v73
    v_dot2c_f32_bf16 v14, s55, v74
    v_dot2c_f32_bf16 v16, v74, v74
    v_dot2c_f32_bf16 v15, s55, v75
    v_dot2c_f32_bf16 v17, v75, v75
    v_dot2c_f32_bf16 v14, s55, v76
    v_dot2c_f32_bf16 v16, v76, v76
    v_dot2c_f32_bf16 v15, s55, v77
    v_dot2c_f32_bf16 v17, v77, v77
    v_dot2c_f32_bf16 v14, s55, v78
    v_dot2c_f32_bf16 v16, v78, v78
    v_dot2c_f32_bf16 v15, s55, v79
    v_dot2c_f32_bf16 v17, v79, v79
    s_waitcnt lgkmcnt(0)
    s_barrier
    ds_read_b128 v[80:83], v56 offset:0
    ds_read_b128 v[84:87], v57 offset:0
    ds_read_b128 v[88:91], v58 offset:0
    ds_read_b128 v[92:95], v59 offset:0
    ds_read_b64_tr_b16 v[168:169], v21 offset:0
    ds_read_b64_tr_b16 v[170:171], v21 offset:256
    ds_read_b64_tr_b16 v[172:173], v21 offset:4096
    ds_read_b64_tr_b16 v[174:175], v21 offset:4352
    ds_read_b64_tr_b16 v[176:177], v21 offset:8192
    ds_read_b64_tr_b16 v[178:179], v21 offset:8448
    v_mfma_f32_32x32x16_bf16 v[96:111], v[156:159], v[76:79], v[96:111]
    v_mfma_f32_32x32x16_bf16 v[112:127], v[160:163], v[76:79], v[112:127]
    v_mfma_f32_32x32x16_bf16 v[128:143], v[76:79], v[164:167], v[128:143]
    s_cmp_eq_u32 s40, 3
    s_cbranch_scc0 qkv1_kernel_cs_20
    v_dot2c_f32_bf16 v18, s55, v156
    v_dot2c_f32_bf16 v19, s55, v160
    v_dot2c_f32_bf16 v20, s55, v164
    v_dot2c_f32_bf16 v18, s55, v157
    v_dot2c_f32_bf16 v19, s55, v161
    v_dot2c_f32_bf16 v20, s55, v165
    v_dot2c_f32_bf16 v18, s55, v158
    v_dot2c_f32_bf16 v19, s55, v162
    v_dot2c_f32_bf16 v20, s55, v166
    v_dot2c_f32_bf16 v18, s55, v159
    v_dot2c_f32_bf16 v19, s55, v163
    v_dot2c_f32_bf16 v20, s55, v167
qkv1_kernel_cs_20:
    s_waitcnt lgkmcnt(0)
    ds_read_b64_tr_b16 v[144:145], v21 offset:1024
    ds_read_b64_tr_b16 v[146:147], v21 offset:1280
    ds_read_b64_tr_b16 v[148:149], v21 offset:5120
    ds_read_b64_tr_b16 v[150:151], v21 offset:5376
    ds_read_b64_tr_b16 v[152:153], v21 offset:9216
    ds_read_b64_tr_b16 v[154:155], v21 offset:9472
    ds_read_b64_tr_b16 v[156:157], v21 offset:2048
    ds_read_b64_tr_b16 v[158:159], v21 offset:2304
    ds_read_b64_tr_b16 v[160:161], v21 offset:6144
    ds_read_b64_tr_b16 v[162:163], v21 offset:6400
    ds_read_b64_tr_b16 v[164:165], v21 offset:10240
    ds_read_b64_tr_b16 v[166:167], v21 offset:10496
    v_mfma_f32_32x32x16_bf16 v[96:111], v[168:171], v[80:83], v[96:111]
    v_mfma_f32_32x32x16_bf16 v[112:127], v[172:175], v[80:83], v[112:127]
    v_mfma_f32_32x32x16_bf16 v[128:143], v[80:83], v[176:179], v[128:143]
    s_cmp_eq_u32 s40, 0
    s_cbranch_scc0 qkv1_kernel_cs_21
    v_dot2c_f32_bf16 v18, s55, v168
    v_dot2c_f32_bf16 v19, s55, v172
    v_dot2c_f32_bf16 v20, s55, v176
    v_dot2c_f32_bf16 v18, s55, v169
    v_dot2c_f32_bf16 v19, s55, v173
    v_dot2c_f32_bf16 v20, s55, v177
    v_dot2c_f32_bf16 v18, s55, v170
    v_dot2c_f32_bf16 v19, s55, v174
    v_dot2c_f32_bf16 v20, s55, v178
    v_dot2c_f32_bf16 v18, s55, v171
    v_dot2c_f32_bf16 v19, s55, v175
    v_dot2c_f32_bf16 v20, s55, v179
qkv1_kernel_cs_21:
    s_waitcnt lgkmcnt(6)
    ds_read_b64_tr_b16 v[168:169], v21 offset:3072
    ds_read_b64_tr_b16 v[170:171], v21 offset:3328
    ds_read_b64_tr_b16 v[172:173], v21 offset:7168
    ds_read_b64_tr_b16 v[174:175], v21 offset:7424
    ds_read_b64_tr_b16 v[176:177], v21 offset:11264
    ds_read_b64_tr_b16 v[178:179], v21 offset:11520
    v_mfma_f32_32x32x16_bf16 v[96:111], v[144:147], v[84:87], v[96:111]
    v_mfma_f32_32x32x16_bf16 v[112:127], v[148:151], v[84:87], v[112:127]
    v_mfma_f32_32x32x16_bf16 v[128:143], v[84:87], v[152:155], v[128:143]
    s_cmp_eq_u32 s40, 1
    s_cbranch_scc0 qkv1_kernel_cs_22
    v_dot2c_f32_bf16 v18, s55, v144
    v_dot2c_f32_bf16 v19, s55, v148
    v_dot2c_f32_bf16 v20, s55, v152
    v_dot2c_f32_bf16 v18, s55, v145
    v_dot2c_f32_bf16 v19, s55, v149
    v_dot2c_f32_bf16 v20, s55, v153
    v_dot2c_f32_bf16 v18, s55, v146
    v_dot2c_f32_bf16 v19, s55, v150
    v_dot2c_f32_bf16 v20, s55, v154
    v_dot2c_f32_bf16 v18, s55, v147
    v_dot2c_f32_bf16 v19, s55, v151
    v_dot2c_f32_bf16 v20, s55, v155
qkv1_kernel_cs_22:
    s_waitcnt lgkmcnt(6)
    v_mfma_f32_32x32x16_bf16 v[96:111], v[156:159], v[88:91], v[96:111]
    v_mfma_f32_32x32x16_bf16 v[112:127], v[160:163], v[88:91], v[112:127]
    v_mfma_f32_32x32x16_bf16 v[128:143], v[88:91], v[164:167], v[128:143]
    s_cmp_eq_u32 s40, 2
    s_cbranch_scc0 qkv1_kernel_cs_23
    v_dot2c_f32_bf16 v18, s55, v156
    v_dot2c_f32_bf16 v19, s55, v160
    v_dot2c_f32_bf16 v20, s55, v164
    v_dot2c_f32_bf16 v18, s55, v157
    v_dot2c_f32_bf16 v19, s55, v161
    v_dot2c_f32_bf16 v20, s55, v165
    v_dot2c_f32_bf16 v18, s55, v158
    v_dot2c_f32_bf16 v19, s55, v162
    v_dot2c_f32_bf16 v20, s55, v166
    v_dot2c_f32_bf16 v18, s55, v159
    v_dot2c_f32_bf16 v19, s55, v163
    v_dot2c_f32_bf16 v20, s55, v167
qkv1_kernel_cs_23:
    v_dot2c_f32_bf16 v14, s55, v80
    v_dot2c_f32_bf16 v16, v80, v80
    v_dot2c_f32_bf16 v15, s55, v81
    v_dot2c_f32_bf16 v17, v81, v81
    v_dot2c_f32_bf16 v14, s55, v82
    v_dot2c_f32_bf16 v16, v82, v82
    v_dot2c_f32_bf16 v15, s55, v83
    v_dot2c_f32_bf16 v17, v83, v83
    v_dot2c_f32_bf16 v14, s55, v84
    v_dot2c_f32_bf16 v16, v84, v84
    v_dot2c_f32_bf16 v15, s55, v85
    v_dot2c_f32_bf16 v17, v85, v85
    v_dot2c_f32_bf16 v14, s55, v86
    v_dot2c_f32_bf16 v16, v86, v86
    v_dot2c_f32_bf16 v15, s55, v87
    v_dot2c_f32_bf16 v17, v87, v87
    v_dot2c_f32_bf16 v14, s55, v88
    v_dot2c_f32_bf16 v16, v88, v88
    v_dot2c_f32_bf16 v15, s55, v89
    v_dot2c_f32_bf16 v17, v89, v89
    v_dot2c_f32_bf16 v14, s55, v90
    v_dot2c_f32_bf16 v16, v90, v90
    v_dot2c_f32_bf16 v15, s55, v91
    v_dot2c_f32_bf16 v17, v91, v91
    v_dot2c_f32_bf16 v14, s55, v92
    v_dot2c_f32_bf16 v16, v92, v92
    v_dot2c_f32_bf16 v15, s55, v93
    v_dot2c_f32_bf16 v17, v93, v93
    v_dot2c_f32_bf16 v14, s55, v94
    v_dot2c_f32_bf16 v16, v94, v94
    v_dot2c_f32_bf16 v15, s55, v95
    v_dot2c_f32_bf16 v17, v95, v95
    s_waitcnt lgkmcnt(0)
    s_barrier
    ds_read_b128 v[64:67], v56 offset:28672
    ds_read_b128 v[68:71], v57 offset:28672
    ds_read_b128 v[72:75], v58 offset:28672
    ds_read_b128 v[76:79], v59 offset:28672
    ds_read_b64_tr_b16 v[144:145], v21 offset:28672
    ds_read_b64_tr_b16 v[146:147], v21 offset:28928
    ds_read_b64_tr_b16 v[148:149], v21 offset:32768
    ds_read_b64_tr_b16 v[150:151], v21 offset:33024
    ds_read_b64_tr_b16 v[152:153], v21 offset:36864
    ds_read_b64_tr_b16 v[154:155], v21 offset:37120
    v_mfma_f32_32x32x16_bf16 v[96:111], v[168:171], v[92:95], v[96:111]
    v_mfma_f32_32x32x16_bf16 v[112:127], v[172:175], v[92:95], v[112:127]
    v_mfma_f32_32x32x16_bf16 v[128:143], v[92:95], v[176:179], v[128:143]
    s_cmp_eq_u32 s40, 3
    s_cbranch_scc0 qkv1_kernel_cs_24
    v_dot2c_f32_bf16 v18, s55, v168
    v_dot2c_f32_bf16 v19, s55, v172
    v_dot2c_f32_bf16 v20, s55, v176
    v_dot2c_f32_bf16 v18, s55, v169
    v_dot2c_f32_bf16 v19, s55, v173
    v_dot2c_f32_bf16 v20, s55, v177
    v_dot2c_f32_bf16 v18, s55, v170
    v_dot2c_f32_bf16 v19, s55, v174
    v_dot2c_f32_bf16 v20, s55, v178
    v_dot2c_f32_bf16 v18, s55, v171
    v_dot2c_f32_bf16 v19, s55, v175
    v_dot2c_f32_bf16 v20, s55, v179
qkv1_kernel_cs_24:
    s_waitcnt lgkmcnt(0)
    ds_read_b64_tr_b16 v[156:157], v21 offset:29696
    ds_read_b64_tr_b16 v[158:159], v21 offset:29952
    ds_read_b64_tr_b16 v[160:161], v21 offset:33792
    ds_read_b64_tr_b16 v[162:163], v21 offset:34048
    ds_read_b64_tr_b16 v[164:165], v21 offset:37888
    ds_read_b64_tr_b16 v[166:167], v21 offset:38144
    ds_read_b64_tr_b16 v[168:169], v21 offset:30720
    ds_read_b64_tr_b16 v[170:171], v21 offset:30976
    ds_read_b64_tr_b16 v[172:173], v21 offset:34816
    ds_read_b64_tr_b16 v[174:175], v21 offset:35072
    ds_read_b64_tr_b16 v[176:177], v21 offset:38912
    ds_read_b64_tr_b16 v[178:179], v21 offset:39168
    v_mfma_f32_32x32x16_bf16 v[96:111], v[144:147], v[64:67], v[96:111]
    v_mfma_f32_32x32x16_bf16 v[112:127], v[148:151], v[64:67], v[112:127]
    v_mfma_f32_32x32x16_bf16 v[128:143], v[64:67], v[152:155], v[128:143]
    s_cmp_eq_u32 s40, 0
    s_cbranch_scc0 qkv1_kernel_cs_25
    v_dot2c_f32_bf16 v18, s55, v144
    v_dot2c_f32_bf16 v19, s55, v148
    v_dot2c_f32_bf16 v20, s55, v152
    v_dot2c_f32_bf16 v18, s55, v145
    v_dot2c_f32_bf16 v19, s55, v149
    v_dot2c_f32_bf16 v20, s55, v153
    v_dot2c_f32_bf16 v18, s55, v146
    v_dot2c_f32_bf16 v19, s55, v150
    v_dot2c_f32_bf16 v20, s55, v154
    v_dot2c_f32_bf16 v18, s55, v147
    v_dot2c_f32_bf16 v19, s55, v151
    v_dot2c_f32_bf16 v20, s55, v155
qkv1_kernel_cs_25:
    s_waitcnt lgkmcnt(6)
    ds_read_b64_tr_b16 v[144:145], v21 offset:31744
    ds_read_b64_tr_b16 v[146:147], v21 offset:32000
    ds_read_b64_tr_b16 v[148:149], v21 offset:35840
    ds_read_b64_tr_b16 v[150:151], v21 offset:36096
    ds_read_b64_tr_b16 v[152:153], v21 offset:39936
    ds_read_b64_tr_b16 v[154:155], v21 offset:40192
    v_mfma_f32_32x32x16_bf16 v[96:111], v[156:159], v[68:71], v[96:111]
    v_mfma_f32_32x32x16_bf16 v[112:127], v[160:163], v[68:71], v[112:127]
    v_mfma_f32_32x32x16_bf16 v[128:143], v[68:71], v[164:167], v[128:143]
    s_cmp_eq_u32 s40, 1
    s_cbranch_scc0 qkv1_kernel_cs_26
    v_dot2c_f32_bf16 v18, s55, v156
    v_dot2c_f32_bf16 v19, s55, v160
    v_dot2c_f32_bf16 v20, s55, v164
    v_dot2c_f32_bf16 v18, s55, v157
    v_dot2c_f32_bf16 v19, s55, v161
    v_dot2c_f32_bf16 v20, s55, v165
    v_dot2c_f32_bf16 v18, s55, v158
    v_dot2c_f32_bf16 v19, s55, v162
    v_dot2c_f32_bf16 v20, s55, v166
    v_dot2c_f32_bf16 v18, s55, v159
    v_dot2c_f32_bf16 v19, s55, v163
    v_dot2c_f32_bf16 v20, s55, v167
qkv1_kernel_cs_26:
    s_waitcnt lgkmcnt(6)
    v_mfma_f32_32x32x16_bf16 v[96:111], v[168:171], v[72:75], v[96:111]
    v_mfma_f32_32x32x16_bf16 v[112:127], v[172:175], v[72:75], v[112:127]
    v_mfma_f32_32x32x16_bf16 v[128:143], v[72:75], v[176:179], v[128:143]
    s_cmp_eq_u32 s40, 2
    s_cbranch_scc0 qkv1_kernel_cs_27
    v_dot2c_f32_bf16 v18, s55, v168
    v_dot2c_f32_bf16 v19, s55, v172
    v_dot2c_f32_bf16 v20, s55, v176
    v_dot2c_f32_bf16 v18, s55, v169
    v_dot2c_f32_bf16 v19, s55, v173
    v_dot2c_f32_bf16 v20, s55, v177
    v_dot2c_f32_bf16 v18, s55, v170
    v_dot2c_f32_bf16 v19, s55, v174
    v_dot2c_f32_bf16 v20, s55, v178
    v_dot2c_f32_bf16 v18, s55, v171
    v_dot2c_f32_bf16 v19, s55, v175
    v_dot2c_f32_bf16 v20, s55, v179
qkv1_kernel_cs_27:
    v_dot2c_f32_bf16 v14, s55, v64
    v_dot2c_f32_bf16 v16, v64, v64
    v_dot2c_f32_bf16 v15, s55, v65
    v_dot2c_f32_bf16 v17, v65, v65
    v_dot2c_f32_bf16 v14, s55, v66
    v_dot2c_f32_bf16 v16, v66, v66
    v_dot2c_f32_bf16 v15, s55, v67
    v_dot2c_f32_bf16 v17, v67, v67
    v_dot2c_f32_bf16 v14, s55, v68
    v_dot2c_f32_bf16 v16, v68, v68
    v_dot2c_f32_bf16 v15, s55, v69
    v_dot2c_f32_bf16 v17, v69, v69
    v_dot2c_f32_bf16 v14, s55, v70
    v_dot2c_f32_bf16 v16, v70, v70
    v_dot2c_f32_bf16 v15, s55, v71
    v_dot2c_f32_bf16 v17, v71, v71
    v_dot2c_f32_bf16 v14, s55, v72
    v_dot2c_f32_bf16 v16, v72, v72
    v_dot2c_f32_bf16 v15, s55, v73
    v_dot2c_f32_bf16 v17, v73, v73
    v_dot2c_f32_bf16 v14, s55, v74
    v_dot2c_f32_bf16 v16, v74, v74
    v_dot2c_f32_bf16 v15, s55, v75
    v_dot2c_f32_bf16 v17, v75, v75
    v_dot2c_f32_bf16 v14, s55, v76
    v_dot2c_f32_bf16 v16, v76, v76
    v_dot2c_f32_bf16 v15, s55, v77
    v_dot2c_f32_bf16 v17, v77, v77
    v_dot2c_f32_bf16 v14, s55, v78
    v_dot2c_f32_bf16 v16, v78, v78
    v_dot2c_f32_bf16 v15, s55, v79
    v_dot2c_f32_bf16 v17, v79, v79
    s_waitcnt lgkmcnt(0)
    s_barrier
    ds_read_b128 v[80:83], v60 offset:0
    ds_read_b128 v[84:87], v61 offset:0
    ds_read_b128 v[88:91], v62 offset:0
    ds_read_b128 v[92:95], v63 offset:0
    ds_read_b64_tr_b16 v[156:157], v22 offset:0
    ds_read_b64_tr_b16 v[158:159], v22 offset:256
    ds_read_b64_tr_b16 v[160:161], v22 offset:4096
    ds_read_b64_tr_b16 v[162:163], v22 offset:4352
    ds_read_b64_tr_b16 v[164:165], v22 offset:8192
    ds_read_b64_tr_b16 v[166:167], v22 offset:8448
    v_mfma_f32_32x32x16_bf16 v[96:111], v[144:147], v[76:79], v[96:111]
    v_mfma_f32_32x32x16_bf16 v[112:127], v[148:151], v[76:79], v[112:127]
    v_mfma_f32_32x32x16_bf16 v[128:143], v[76:79], v[152:155], v[128:143]
    s_cmp_eq_u32 s40, 3
    s_cbranch_scc0 qkv1_kernel_cs_28
    v_dot2c_f32_bf16 v18, s55, v144
    v_dot2c_f32_bf16 v19, s55, v148
    v_dot2c_f32_bf16 v20, s55, v152
    v_dot2c_f32_bf16 v18, s55, v145
    v_dot2c_f32_bf16 v19, s55, v149
    v_dot2c_f32_bf16 v20, s55, v153
    v_dot2c_f32_bf16 v18, s55, v146
    v_dot2c_f32_bf16 v19, s55, v150
    v_dot2c_f32_bf16 v20, s55, v154
    v_dot2c_f32_bf16 v18, s55, v147
    v_dot2c_f32_bf16 v19, s55, v151
    v_dot2c_f32_bf16 v20, s55, v155
qkv1_kernel_cs_28:
    s_waitcnt lgkmcnt(0)
    ds_read_b64_tr_b16 v[168:169], v22 offset:1024
    ds_read_b64_tr_b16 v[170:171], v22 offset:1280
    ds_read_b64_tr_b16 v[172:173], v22 offset:5120
    ds_read_b64_tr_b16 v[174:175], v22 offset:5376
    ds_read_b64_tr_b16 v[176:177], v22 offset:9216
    ds_read_b64_tr_b16 v[178:179], v22 offset:9472
    ds_read_b64_tr_b16 v[144:145], v22 offset:2048
    ds_read_b64_tr_b16 v[146:147], v22 offset:2304
    ds_read_b64_tr_b16 v[148:149], v22 offset:6144
    ds_read_b64_tr_b16 v[150:151], v22 offset:6400
    ds_read_b64_tr_b16 v[152:153], v22 offset:10240
    ds_read_b64_tr_b16 v[154:155], v22 offset:10496
    v_mfma_f32_32x32x16_bf16 v[96:111], v[156:159], v[80:83], v[96:111]
    v_mfma_f32_32x32x16_bf16 v[112:127], v[160:163], v[80:83], v[112:127]
    v_mfma_f32_32x32x16_bf16 v[128:143], v[80:83], v[164:167], v[128:143]
    s_cmp_eq_u32 s40, 0
    s_cbranch_scc0 qkv1_kernel_cs_29
    v_dot2c_f32_bf16 v18, s55, v156
    v_dot2c_f32_bf16 v19, s55, v160
    v_dot2c_f32_bf16 v20, s55, v164
    v_dot2c_f32_bf16 v18, s55, v157
    v_dot2c_f32_bf16 v19, s55, v161
    v_dot2c_f32_bf16 v20, s55, v165
    v_dot2c_f32_bf16 v18, s55, v158
    v_dot2c_f32_bf16 v19, s55, v162
    v_dot2c_f32_bf16 v20, s55, v166
    v_dot2c_f32_bf16 v18, s55, v159
    v_dot2c_f32_bf16 v19, s55, v163
    v_dot2c_f32_bf16 v20, s55, v167
qkv1_kernel_cs_29:
    s_waitcnt lgkmcnt(6)
    ds_read_b64_tr_b16 v[156:157], v22 offset:3072
    ds_read_b64_tr_b16 v[158:159], v22 offset:3328
    ds_read_b64_tr_b16 v[160:161], v22 offset:7168
    ds_read_b64_tr_b16 v[162:163], v22 offset:7424
    ds_read_b64_tr_b16 v[164:165], v22 offset:11264
    ds_read_b64_tr_b16 v[166:167], v22 offset:11520
    v_mfma_f32_32x32x16_bf16 v[96:111], v[168:171], v[84:87], v[96:111]
    v_mfma_f32_32x32x16_bf16 v[112:127], v[172:175], v[84:87], v[112:127]
    v_mfma_f32_32x32x16_bf16 v[128:143], v[84:87], v[176:179], v[128:143]
    s_cmp_eq_u32 s40, 1
    s_cbranch_scc0 qkv1_kernel_cs_30
    v_dot2c_f32_bf16 v18, s55, v168
    v_dot2c_f32_bf16 v19, s55, v172
    v_dot2c_f32_bf16 v20, s55, v176
    v_dot2c_f32_bf16 v18, s55, v169
    v_dot2c_f32_bf16 v19, s55, v173
    v_dot2c_f32_bf16 v20, s55, v177
    v_dot2c_f32_bf16 v18, s55, v170
    v_dot2c_f32_bf16 v19, s55, v174
    v_dot2c_f32_bf16 v20, s55, v178
    v_dot2c_f32_bf16 v18, s55, v171
    v_dot2c_f32_bf16 v19, s55, v175
    v_dot2c_f32_bf16 v20, s55, v179
qkv1_kernel_cs_30:
    s_waitcnt lgkmcnt(6)
    v_mfma_f32_32x32x16_bf16 v[96:111], v[144:147], v[88:91], v[96:111]
    v_mfma_f32_32x32x16_bf16 v[112:127], v[148:151], v[88:91], v[112:127]
    v_mfma_f32_32x32x16_bf16 v[128:143], v[88:91], v[152:155], v[128:143]
    s_cmp_eq_u32 s40, 2
    s_cbranch_scc0 qkv1_kernel_cs_31
    v_dot2c_f32_bf16 v18, s55, v144
    v_dot2c_f32_bf16 v19, s55, v148
    v_dot2c_f32_bf16 v20, s55, v152
    v_dot2c_f32_bf16 v18, s55, v145
    v_dot2c_f32_bf16 v19, s55, v149
    v_dot2c_f32_bf16 v20, s55, v153
    v_dot2c_f32_bf16 v18, s55, v146
    v_dot2c_f32_bf16 v19, s55, v150
    v_dot2c_f32_bf16 v20, s55, v154
    v_dot2c_f32_bf16 v18, s55, v147
    v_dot2c_f32_bf16 v19, s55, v151
    v_dot2c_f32_bf16 v20, s55, v155
qkv1_kernel_cs_31:
    v_dot2c_f32_bf16 v14, s55, v80
    v_dot2c_f32_bf16 v16, v80, v80
    v_dot2c_f32_bf16 v15, s55, v81
    v_dot2c_f32_bf16 v17, v81, v81
    v_dot2c_f32_bf16 v14, s55, v82
    v_dot2c_f32_bf16 v16, v82, v82
    v_dot2c_f32_bf16 v15, s55, v83
    v_dot2c_f32_bf16 v17, v83, v83
    v_dot2c_f32_bf16 v14, s55, v84
    v_dot2c_f32_bf16 v16, v84, v84
    v_dot2c_f32_bf16 v15, s55, v85
    v_dot2c_f32_bf16 v17, v85, v85
    v_dot2c_f32_bf16 v14, s55, v86
    v_dot2c_f32_bf16 v16, v86, v86
    v_dot2c_f32_bf16 v15, s55, v87
    v_dot2c_f32_bf16 v17, v87, v87
    v_dot2c_f32_bf16 v14, s55, v88
    v_dot2c_f32_bf16 v16, v88, v88
    v_dot2c_f32_bf16 v15, s55, v89
    v_dot2c_f32_bf16 v17, v89, v89
    v_dot2c_f32_bf16 v14, s55, v90
    v_dot2c_f32_bf16 v16, v90, v90
    v_dot2c_f32_bf16 v15, s55, v91
    v_dot2c_f32_bf16 v17, v91, v91
    v_dot2c_f32_bf16 v14, s55, v92
    v_dot2c_f32_bf16 v16, v92, v92
    v_dot2c_f32_bf16 v15, s55, v93
    v_dot2c_f32_bf16 v17, v93, v93
    v_dot2c_f32_bf16 v14, s55, v94
    v_dot2c_f32_bf16 v16, v94, v94
    v_dot2c_f32_bf16 v15, s55, v95
    v_dot2c_f32_bf16 v17, v95, v95
    s_waitcnt lgkmcnt(0)
    v_mfma_f32_32x32x16_bf16 v[96:111], v[156:159], v[92:95], v[96:111]
    v_mfma_f32_32x32x16_bf16 v[112:127], v[160:163], v[92:95], v[112:127]
    v_mfma_f32_32x32x16_bf16 v[128:143], v[92:95], v[164:167], v[128:143]
    s_cmp_eq_u32 s40, 3
    s_cbranch_scc0 qkv1_kernel_cs_32
    v_dot2c_f32_bf16 v18, s55, v156
    v_dot2c_f32_bf16 v19, s55, v160
    v_dot2c_f32_bf16 v20, s55, v164
    v_dot2c_f32_bf16 v18, s55, v157
    v_dot2c_f32_bf16 v19, s55, v161
    v_dot2c_f32_bf16 v20, s55, v165
    v_dot2c_f32_bf16 v18, s55, v158
    v_dot2c_f32_bf16 v19, s55, v162
    v_dot2c_f32_bf16 v20, s55, v166
    v_dot2c_f32_bf16 v18, s55, v159
    v_dot2c_f32_bf16 v19, s55, v163
    v_dot2c_f32_bf16 v20, s55, v167
qkv1_kernel_cs_32:
    s_nop 2
    v_add_f32 v14, v14, v15
    v_add_f32 v16, v16, v17
    v_mov_b32 v57, v18
    v_mov_b32 v58, v19
    v_mov_b32 v59, v20
    v_lshl_add_u32 v12, v4, 2, s50
    s_nop 0
    v_permlane32_swap_b32 v18, v57
    v_permlane32_swap_b32 v19, v58
    v_permlane32_swap_b32 v20, v59
    s_nop 0
    v_add_f32 v18, v18, v57
    v_add_f32 v19, v19, v58
    v_add_f32 v20, v20, v59
    ds_write_b32 v12, v18
    ds_write_b32 v12, v19 offset:128
    ds_write_b32 v12, v20 offset:256

    v_mov_b32 v15, v14
    v_mov_b32 v17, v16
    v_lshl_add_u32 v12, v4, 2, s50
    v_lshl_add_u32 v11, v3, 4, s50
    v_permlane32_swap_b32 v14, v15
    v_permlane32_swap_b32 v16, v17
    s_mov_b32 s56, 0x3b000000
    s_nop 0
    v_add_f32 v14, v14, v15
    v_add_f32 v16, v16, v17

    s_mov_b32 s56, 0x3b000000
    v_mul_f32 v14, s56, v14
    v_mul_f32 v16, s56, v16
    v_fma_f32 v16, -v14, v14, v16
    v_max_f32 v16, 0, v16
    v_cvt_pk_bf16_f32 v15, v14, v16
    v_lshlrev_b32 v14, 16, v15
    v_and_b32 v16, 0xffff0000, v15
    v_add_f32 v16, 0x3727c5ac, v16
    v_cvt_pk_bf16_f32 v15, v16, v16
    v_and_b32 v16, 0xffff0000, v15
    v_sqrt_f32 v16, v16
    s_nop 0
    v_cvt_pk_bf16_f32 v15, v16, v16
    v_and_b32 v16, 0xffff0000, v15
    v_rcp_f32 v16, v16
    s_nop 0
    v_mul_f32 v17, v14, v16
    v_sub_f32 v17, 0, v17

    ds_write_b32 v12, v16 offset:512
    ds_write_b32 v12, v17 offset:640
    s_waitcnt lgkmcnt(0)

    ds_read_b128 v[180:183], v11 offset:512
    ds_read_b128 v[196:199], v11 offset:640
    ds_read_b128 v[184:187], v11 offset:544
    ds_read_b128 v[200:203], v11 offset:672
    ds_read_b128 v[188:191], v11 offset:576
    ds_read_b128 v[204:207], v11 offset:704
    ds_read_b128 v[192:195], v11 offset:608
    ds_read_b128 v[208:211], v11 offset:736
    s_barrier
    v_lshlrev_b32 v10, 2, v4
    v_add_u32 v13, 143360, v10

    ds_read_b32 v64, v13 offset:0
    ds_read_b32 v65, v13 offset:2048
    ds_read_b32 v66, v13 offset:4096
    ds_read_b32 v67, v13 offset:6144
    ds_read_b32 v68, v13 offset:128
    ds_read_b32 v69, v13 offset:2176
    ds_read_b32 v70, v13 offset:4224
    ds_read_b32 v71, v13 offset:6272
    ds_read_b32 v72, v13 offset:256
    ds_read_b32 v73, v13 offset:2304
    ds_read_b32 v74, v13 offset:4352
    ds_read_b32 v75, v13 offset:6400
    s_waitcnt lgkmcnt(0)
    v_add_f32 v64, v64, v65
    v_add_f32 v66, v66, v67
    v_add_f32 v18, v64, v66
    v_add_f32 v68, v68, v69
    v_add_f32 v70, v70, v71
    v_add_f32 v19, v68, v70
    v_add_f32 v72, v72, v73
    v_add_f32 v74, v74, v75
    v_add_f32 v20, v72, v74
    ds_write_b32 v12, v18 offset:1024
    ds_write_b32 v12, v19 offset:1152

    s_cmp_lg_u32 s43, 0
    s_cbranch_scc1 qkv1_kernel_cst_33
    s_lshl_b32 s51, s42, 7
    s_add_u32 s51, s51, 0x1500000
    buffer_store_dword v18, v10, s[24:27], s51 offen
    buffer_store_dword v19, v10, s[24:27], s51 offen offset:2048
    s_add_u32 s51, s51, 4096
    buffer_store_dword v20, v10, s[24:27], s51 offen

qkv1_kernel_cst_33:
    s_waitcnt lgkmcnt(0)
    ds_read_b128 v[24:27], v11 offset:1024
    ds_read_b128 v[40:43], v11 offset:1152
    ds_read_b128 v[28:31], v11 offset:1056
    ds_read_b128 v[44:47], v11 offset:1184
    ds_read_b128 v[32:35], v11 offset:1088
    ds_read_b128 v[48:51], v11 offset:1216
    ds_read_b128 v[36:39], v11 offset:1120
    ds_read_b128 v[52:55], v11 offset:1248
    s_mov_b32 s56, 0x3eb8aa3b
    v_mul_f32 v56, s56, v16
    v_mul_f32 v58, s56, v17
    v_mov_b32 v57, v56
    v_mov_b32 v59, v58
    v_mov_b32 v60, v16
    v_mov_b32 v61, v16
    v_mov_b32 v62, v17
    v_mov_b32 v63, v17
    s_waitcnt vmcnt(0)
    v_mov_b32 v21, v20
    s_lshl_b32 s57, s42, 17
    s_lshl_b32 s58, s43, 10
    s_add_u32 s57, s57, s58
    v_and_b32 v10, 3, v1
    v_bfe_u32 v11, v1, 2, 1
    v_lshl_or_b32 v10, v11, 3, v10
    v_bfe_u32 v11, v1, 3, 1
    v_lshl_or_b32 v10, v11, 2, v10
    v_lshlrev_b32 v10, 4, v10
    v_lshl_or_b32 v10, v3, 8, v10
    v_bfe_u32 v11, v1, 4, 1
    v_lshl_or_b32 v10, v11, 16, v10
    s_waitcnt lgkmcnt(0)

    v_pk_mul_f32 v[112:113], v[112:113], v[60:61]
    v_pk_mul_f32 v[114:115], v[114:115], v[60:61]
    v_pk_mul_f32 v[116:117], v[116:117], v[60:61]
    v_pk_mul_f32 v[118:119], v[118:119], v[60:61]
    v_pk_mul_f32 v[120:121], v[120:121], v[60:61]
    v_pk_mul_f32 v[122:123], v[122:123], v[60:61]
    v_pk_mul_f32 v[124:125], v[124:125], v[60:61]
    v_pk_mul_f32 v[126:127], v[126:127], v[60:61]
    v_pk_fma_f32 v[112:113], v[40:41], v[62:63], v[112:113]
    v_pk_fma_f32 v[114:115], v[42:43], v[62:63], v[114:115]
    v_pk_fma_f32 v[116:117], v[44:45], v[62:63], v[116:117]
    v_pk_fma_f32 v[118:119], v[46:47], v[62:63], v[118:119]
    v_pk_fma_f32 v[120:121], v[48:49], v[62:63], v[120:121]
    v_pk_fma_f32 v[122:123], v[50:51], v[62:63], v[122:123]
    v_pk_fma_f32 v[124:125], v[52:53], v[62:63], v[124:125]
    v_pk_fma_f32 v[126:127], v[54:55], v[62:63], v[126:127]
    v_cvt_pk_bf16_f32 v72, v112, v113
    v_cvt_pk_bf16_f32 v73, v114, v115
    v_cvt_pk_bf16_f32 v74, v116, v117
    v_cvt_pk_bf16_f32 v75, v118, v119
    v_cvt_pk_bf16_f32 v76, v120, v121
    v_cvt_pk_bf16_f32 v77, v122, v123
    v_cvt_pk_bf16_f32 v78, v124, v125
    v_cvt_pk_bf16_f32 v79, v126, v127
    v_min_u32 v72, s67, v72
    v_min_u32 v73, s67, v73
    v_min_u32 v74, s67, v74
    v_min_u32 v75, s67, v75
    v_min_u32 v76, s67, v76
    v_min_u32 v77, s67, v77
    v_min_u32 v78, s67, v78
    v_min_u32 v79, s67, v79
    s_add_u32 s58, s57, 0x200000
    buffer_store_dwordx4 v[72:75], v9, s[24:27], s58 offen
    s_add_u32 s58, s57, 0x210000
    buffer_store_dwordx4 v[76:79], v9, s[24:27], s58 offen
    v_pk_mul_f32 v[96:97], v[96:97], v[56:57]
    v_pk_mul_f32 v[98:99], v[98:99], v[56:57]
    v_pk_mul_f32 v[100:101], v[100:101], v[56:57]
    v_pk_mul_f32 v[102:103], v[102:103], v[56:57]
    v_pk_mul_f32 v[104:105], v[104:105], v[56:57]
    v_pk_mul_f32 v[106:107], v[106:107], v[56:57]
    v_pk_mul_f32 v[108:109], v[108:109], v[56:57]
    v_pk_mul_f32 v[110:111], v[110:111], v[56:57]
    v_pk_fma_f32 v[96:97], v[24:25], v[58:59], v[96:97]
    v_pk_fma_f32 v[98:99], v[26:27], v[58:59], v[98:99]
    v_pk_fma_f32 v[100:101], v[28:29], v[58:59], v[100:101]
    v_pk_fma_f32 v[102:103], v[30:31], v[58:59], v[102:103]
    v_pk_fma_f32 v[104:105], v[32:33], v[58:59], v[104:105]
    v_pk_fma_f32 v[106:107], v[34:35], v[58:59], v[106:107]
    v_pk_fma_f32 v[108:109], v[36:37], v[58:59], v[108:109]
    v_pk_fma_f32 v[110:111], v[38:39], v[58:59], v[110:111]
    v_cvt_pk_bf16_f32 v64, v96, v97
    v_cvt_pk_bf16_f32 v65, v98, v99
    v_cvt_pk_bf16_f32 v66, v100, v101
    v_cvt_pk_bf16_f32 v67, v102, v103
    v_cvt_pk_bf16_f32 v68, v104, v105
    v_cvt_pk_bf16_f32 v69, v106, v107
    v_cvt_pk_bf16_f32 v70, v108, v109
    v_cvt_pk_bf16_f32 v71, v110, v111
    v_min_u32 v64, s67, v64
    v_min_u32 v65, s67, v65
    v_min_u32 v66, s67, v66
    v_min_u32 v67, s67, v67
    v_min_u32 v68, s67, v68
    v_min_u32 v69, s67, v69
    v_min_u32 v70, s67, v70
    v_min_u32 v71, s67, v71
    s_add_u32 s58, s57, 0x0
    buffer_store_dwordx4 v[64:67], v9, s[24:27], s58 offen
    s_add_u32 s58, s57, 0x10000
    buffer_store_dwordx4 v[68:71], v9, s[24:27], s58 offen
    v_pk_mul_f32 v[128:129], v[128:129], v[180:181]
    v_pk_mul_f32 v[130:131], v[130:131], v[182:183]
    v_pk_mul_f32 v[132:133], v[132:133], v[184:185]
    v_pk_mul_f32 v[134:135], v[134:135], v[186:187]
    v_pk_mul_f32 v[136:137], v[136:137], v[188:189]
    v_pk_mul_f32 v[138:139], v[138:139], v[190:191]
    v_pk_mul_f32 v[140:141], v[140:141], v[192:193]
    v_pk_mul_f32 v[142:143], v[142:143], v[194:195]
    v_pk_fma_f32 v[128:129], v[196:197], v[20:21], v[128:129]
    v_pk_fma_f32 v[130:131], v[198:199], v[20:21], v[130:131]
    v_pk_fma_f32 v[132:133], v[200:201], v[20:21], v[132:133]
    v_pk_fma_f32 v[134:135], v[202:203], v[20:21], v[134:135]
    v_pk_fma_f32 v[136:137], v[204:205], v[20:21], v[136:137]
    v_pk_fma_f32 v[138:139], v[206:207], v[20:21], v[138:139]
    v_pk_fma_f32 v[140:141], v[208:209], v[20:21], v[140:141]
    v_pk_fma_f32 v[142:143], v[210:211], v[20:21], v[142:143]
    v_cvt_pk_bf16_f32 v80, v128, v129
    v_cvt_pk_bf16_f32 v81, v130, v131
    v_cvt_pk_bf16_f32 v82, v132, v133
    v_cvt_pk_bf16_f32 v83, v134, v135
    v_cvt_pk_bf16_f32 v84, v136, v137
    v_cvt_pk_bf16_f32 v85, v138, v139
    v_cvt_pk_bf16_f32 v86, v140, v141
    v_cvt_pk_bf16_f32 v87, v142, v143
    v_min_u32 v80, s67, v80
    v_min_u32 v81, s67, v81
    v_min_u32 v82, s67, v82
    v_min_u32 v83, s67, v83
    v_min_u32 v84, s67, v84
    v_min_u32 v85, s67, v85
    v_min_u32 v86, s67, v86
    v_min_u32 v87, s67, v87
    s_add_u32 s58, s57, 0x400000
    buffer_store_dwordx4 v[80:83], v10, s[24:27], s58 offen
    buffer_store_dwordx4 v[84:87], v10, s[24:27], s58 offen offset:512

qkv1_kernel_done:
    s_endpgm
qkv1_kernel_loader:
    v_lshrrev_b32 v11, 2, v1
    s_movk_i32 s52, 3072
    v_mul_lo_u32 v11, v11, s52
    v_and_b32 v12, 3, v1
    v_lshl_add_u32 v11, v12, 4, v11
    s_lshl_b32 s52, s42, 6
    s_mul_i32 s53, s39, 49152
    s_add_u32 s52, s52, s53
    s_lshl_b32 s53, s39, 10
    s_lshl_b32 s54, s39, 12
    s_add_u32 s54, s54, 12288

    v_lshrrev_b32 v13, 3, v1
    v_lshrrev_b32 v14, 4, v1
    v_and_b32 v15, 7, v1
    v_xor_b32 v15, v15, v14
    v_lshlrev_b32 v15, 4, v15
    v_lshl_add_u32 v15, v13, 10, v15
    v_xor_b32 v16, 64, v15

    s_waitcnt lgkmcnt(0)
    s_mov_b32 s20, s6
    s_mov_b32 s21, s7
    s_mov_b32 s22, 0x180000
    s_mov_b32 s23, 0x00020000
    s_mov_b32 s16, s4
    s_mov_b32 s17, s5
    s_mov_b32 s18, 0x200000
    s_mov_b32 s19, 0x00020000
    s_mov_b32 s24, s14
    s_mov_b32 s25, s15
    s_mov_b32 s26, 0x2600000
    s_mov_b32 s27, 0x00020000
    s_add_u32 m0, s54, 0
    s_add_u32 s51, s49, 0
    buffer_load_dwordx4 v15, s[16:19], s51 offen lds
    s_add_u32 m0, s53, 0
    s_add_u32 s51, s52, 0
    buffer_load_dwordx4 v11, s[20:23], s51 offen lds
    s_add_u32 m0, s54, 1024
    s_add_u32 s51, s49, 8192
    buffer_load_dwordx4 v16, s[16:19], s51 offen lds
    s_add_u32 m0, s53, 4096
    s_add_u32 s51, s52, 1024
    buffer_load_dwordx4 v11, s[20:23], s51 offen lds
    s_add_u32 m0, s54, 2048
    s_add_u32 s51, s49, 16384
    buffer_load_dwordx4 v15, s[16:19], s51 offen lds
    s_add_u32 m0, s53, 8192
    s_add_u32 s51, s52, 2048
    buffer_load_dwordx4 v11, s[20:23], s51 offen lds
    s_add_u32 m0, s54, 3072
    s_add_u32 s51, s49, 24576
    buffer_load_dwordx4 v16, s[16:19], s51 offen lds
    s_add_u32 m0, s54, 28672
    s_add_u32 s51, s49, 128
    buffer_load_dwordx4 v15, s[16:19], s51 offen lds
    s_add_u32 m0, s53, 28672
    s_add_u32 s51, s52, 196608
    buffer_load_dwordx4 v11, s[20:23], s51 offen lds
    s_add_u32 m0, s54, 29696
    s_add_u32 s51, s49, 8320
    buffer_load_dwordx4 v16, s[16:19], s51 offen lds
    s_add_u32 m0, s53, 32768
    s_add_u32 s51, s52, 197632
    buffer_load_dwordx4 v11, s[20:23], s51 offen lds
    s_add_u32 m0, s54, 30720
    s_add_u32 s51, s49, 16512
    buffer_load_dwordx4 v15, s[16:19], s51 offen lds
    s_add_u32 m0, s53, 36864
    s_add_u32 s51, s52, 198656
    buffer_load_dwordx4 v11, s[20:23], s51 offen lds
    s_add_u32 m0, s54, 31744
    s_add_u32 s51, s49, 24704
    buffer_load_dwordx4 v16, s[16:19], s51 offen lds
    s_add_u32 m0, s54, 57344
    s_add_u32 s51, s49, 256
    buffer_load_dwordx4 v15, s[16:19], s51 offen lds
    s_add_u32 m0, s53, 57344
    s_add_u32 s51, s52, 393216
    buffer_load_dwordx4 v11, s[20:23], s51 offen lds
    s_add_u32 m0, s54, 58368
    s_add_u32 s51, s49, 8448
    buffer_load_dwordx4 v16, s[16:19], s51 offen lds
    s_add_u32 m0, s53, 61440
    s_add_u32 s51, s52, 394240
    buffer_load_dwordx4 v11, s[20:23], s51 offen lds
    s_add_u32 m0, s54, 59392
    s_add_u32 s51, s49, 16640
    buffer_load_dwordx4 v15, s[16:19], s51 offen lds
    s_add_u32 m0, s53, 65536
    s_add_u32 s51, s52, 395264
    buffer_load_dwordx4 v11, s[20:23], s51 offen lds
    s_add_u32 m0, s54, 60416
    s_add_u32 s51, s49, 24832
    buffer_load_dwordx4 v16, s[16:19], s51 offen lds
    s_waitcnt vmcnt(14)
    s_barrier
    s_add_u32 m0, s54, 86016
    s_add_u32 s51, s49, 384
    buffer_load_dwordx4 v15, s[16:19], s51 offen lds
    s_add_u32 m0, s53, 86016
    s_add_u32 s51, s52, 589824
    buffer_load_dwordx4 v11, s[20:23], s51 offen lds
    s_add_u32 m0, s54, 87040
    s_add_u32 s51, s49, 8576
    buffer_load_dwordx4 v16, s[16:19], s51 offen lds
    s_add_u32 m0, s53, 90112
    s_add_u32 s51, s52, 590848
    buffer_load_dwordx4 v11, s[20:23], s51 offen lds
    s_add_u32 m0, s54, 88064
    s_add_u32 s51, s49, 16768
    buffer_load_dwordx4 v15, s[16:19], s51 offen lds
    s_add_u32 m0, s53, 94208
    s_add_u32 s51, s52, 591872
    buffer_load_dwordx4 v11, s[20:23], s51 offen lds
    s_add_u32 m0, s54, 89088
    s_add_u32 s51, s49, 24960
    buffer_load_dwordx4 v16, s[16:19], s51 offen lds
    s_waitcnt vmcnt(14)
    s_barrier
    s_add_u32 m0, s54, 114688
    s_add_u32 s51, s49, 512
    buffer_load_dwordx4 v15, s[16:19], s51 offen lds
    s_add_u32 m0, s53, 114688
    s_add_u32 s51, s52, 786432
    buffer_load_dwordx4 v11, s[20:23], s51 offen lds
    s_add_u32 m0, s54, 115712
    s_add_u32 s51, s49, 8704
    buffer_load_dwordx4 v16, s[16:19], s51 offen lds
    s_add_u32 m0, s53, 118784
    s_add_u32 s51, s52, 787456
    buffer_load_dwordx4 v11, s[20:23], s51 offen lds
    s_add_u32 m0, s54, 116736
    s_add_u32 s51, s49, 16896
    buffer_load_dwordx4 v15, s[16:19], s51 offen lds
    s_add_u32 m0, s53, 122880
    s_add_u32 s51, s52, 788480
    buffer_load_dwordx4 v11, s[20:23], s51 offen lds
    s_add_u32 m0, s54, 117760
    s_add_u32 s51, s49, 25088
    buffer_load_dwordx4 v16, s[16:19], s51 offen lds
    s_waitcnt vmcnt(14)
    s_barrier
    s_add_u32 m0, s54, 0
    s_add_u32 s51, s49, 640
    buffer_load_dwordx4 v15, s[16:19], s51 offen lds
    s_add_u32 m0, s53, 0
    s_add_u32 s51, s52, 983040
    buffer_load_dwordx4 v11, s[20:23], s51 offen lds
    s_add_u32 m0, s54, 1024
    s_add_u32 s51, s49, 8832
    buffer_load_dwordx4 v16, s[16:19], s51 offen lds
    s_add_u32 m0, s53, 4096
    s_add_u32 s51, s52, 984064
    buffer_load_dwordx4 v11, s[20:23], s51 offen lds
    s_add_u32 m0, s54, 2048
    s_add_u32 s51, s49, 17024
    buffer_load_dwordx4 v15, s[16:19], s51 offen lds
    s_add_u32 m0, s53, 8192
    s_add_u32 s51, s52, 985088
    buffer_load_dwordx4 v11, s[20:23], s51 offen lds
    s_add_u32 m0, s54, 3072
    s_add_u32 s51, s49, 25216
    buffer_load_dwordx4 v16, s[16:19], s51 offen lds
    s_mov_b32 s28, s8
    s_mov_b32 s29, s9
    s_mov_b32 s30, 0x200000
    s_mov_b32 s31, 0x00020000
    s_mov_b32 s32, s10
    s_mov_b32 s33, s11
    s_mov_b32 s34, 0x200000
    s_mov_b32 s35, 0x00020000
    s_mov_b32 s64, s12
    s_mov_b32 s65, s13
    s_mov_b32 s66, 0x1000
    s_mov_b32 s67, 0x00020000
    s_lshr_b32 s46, s2, 3
    s_lshl_b32 s46, s46, 16
    s_lshl_b32 s47, s39, 14
    s_add_u32 s46, s46, s47
    s_and_b32 s47, s2, 7
    s_lshl_b32 s48, s47, 7
    s_add_u32 s46, s46, s48
    v_lshlrev_b32 v5, 13, v3
    v_lshl_add_u32 v5, v4, 2, v5
    v_add_u32 v5, s46, v5
    v_add_u32 v6, 0x1000, v5
    v_subrev_u32 v7, 0xc00, v5
    s_lshl_b32 s48, s47, 9
    v_lshl_add_u32 v8, v4, 4, s48

    buffer_load_dword v24, v7, s[28:31], 0 offen offset:0
    buffer_load_dword v25, v7, s[28:31], 0 offen offset:1024
    buffer_load_dword v26, v7, s[28:31], 0 offen offset:2048
    buffer_load_dword v27, v5, s[28:31], 0 offen offset:0
    buffer_load_dword v28, v5, s[28:31], 0 offen offset:1024
    buffer_load_dword v29, v5, s[28:31], 0 offen offset:2048
    buffer_load_dword v30, v5, s[28:31], 0 offen offset:3072
    buffer_load_dword v31, v6, s[28:31], 0 offen offset:0
    buffer_load_dword v32, v6, s[28:31], 0 offen offset:1024
    buffer_load_dword v33, v6, s[28:31], 0 offen offset:2048
    buffer_load_dword v34, v6, s[28:31], 0 offen offset:3072
    buffer_load_dword v35, v5, s[32:35], 0 offen offset:0
    buffer_load_dword v36, v5, s[32:35], 0 offen offset:1024
    buffer_load_dword v37, v5, s[32:35], 0 offen offset:2048
    buffer_load_dword v38, v5, s[32:35], 0 offen offset:3072
    buffer_load_dword v39, v6, s[32:35], 0 offen offset:0
    buffer_load_dword v40, v6, s[32:35], 0 offen offset:1024
    buffer_load_dword v41, v6, s[32:35], 0 offen offset:2048
    buffer_load_dword v42, v6, s[32:35], 0 offen offset:3072
    buffer_load_dwordx4 v[44:47], v8, s[64:67], 0 offen
    s_waitcnt vmcnt(34)
    s_barrier
    s_add_u32 m0, s54, 28672
    s_add_u32 s51, s49, 768
    buffer_load_dwordx4 v15, s[16:19], s51 offen lds
    s_add_u32 m0, s53, 28672
    s_add_u32 s51, s52, 1179648
    buffer_load_dwordx4 v11, s[20:23], s51 offen lds
    s_add_u32 m0, s54, 29696
    s_add_u32 s51, s49, 8960
    buffer_load_dwordx4 v16, s[16:19], s51 offen lds
    s_add_u32 m0, s53, 32768
    s_add_u32 s51, s52, 1180672
    buffer_load_dwordx4 v11, s[20:23], s51 offen lds
    s_add_u32 m0, s54, 30720
    s_add_u32 s51, s49, 17152
    buffer_load_dwordx4 v15, s[16:19], s51 offen lds
    s_add_u32 m0, s53, 36864
    s_add_u32 s51, s52, 1181696
    buffer_load_dwordx4 v11, s[20:23], s51 offen lds
    s_add_u32 m0, s54, 31744
    s_add_u32 s51, s49, 25344
    buffer_load_dwordx4 v16, s[16:19], s51 offen lds
    s_waitcnt vmcnt(34)
    s_barrier
    s_add_u32 m0, s54, 57344
    s_add_u32 s51, s49, 896
    buffer_load_dwordx4 v15, s[16:19], s51 offen lds
    s_add_u32 m0, s53, 57344
    s_add_u32 s51, s52, 1376256
    buffer_load_dwordx4 v11, s[20:23], s51 offen lds
    s_add_u32 m0, s54, 58368
    s_add_u32 s51, s49, 9088
    buffer_load_dwordx4 v16, s[16:19], s51 offen lds
    s_add_u32 m0, s53, 61440
    s_add_u32 s51, s52, 1377280
    buffer_load_dwordx4 v11, s[20:23], s51 offen lds
    s_add_u32 m0, s54, 59392
    s_add_u32 s51, s49, 17280
    buffer_load_dwordx4 v15, s[16:19], s51 offen lds
    s_add_u32 m0, s53, 65536
    s_add_u32 s51, s52, 1378304
    buffer_load_dwordx4 v11, s[20:23], s51 offen lds
    s_add_u32 m0, s54, 60416
    s_add_u32 s51, s49, 25472
    buffer_load_dwordx4 v16, s[16:19], s51 offen lds
    s_waitcnt vmcnt(34)
    s_barrier
    s_waitcnt vmcnt(7)
    s_barrier
    v_lshlrev_b32 v48, 16, v24
    v_and_b32 v49, 0xffff0000, v24
    v_lshlrev_b32 v50, 16, v25
    v_and_b32 v51, 0xffff0000, v25
    v_lshlrev_b32 v52, 16, v26
    v_and_b32 v53, 0xffff0000, v26
    v_lshlrev_b32 v54, 16, v27
    v_and_b32 v55, 0xffff0000, v27
    v_lshlrev_b32 v56, 16, v28
    v_and_b32 v57, 0xffff0000, v28
    v_lshlrev_b32 v58, 16, v29
    v_and_b32 v59, 0xffff0000, v29
    v_lshlrev_b32 v60, 16, v30
    v_and_b32 v61, 0xffff0000, v30
    v_lshlrev_b32 v62, 16, v31
    v_and_b32 v63, 0xffff0000, v31
    v_lshlrev_b32 v64, 16, v32
    v_and_b32 v65, 0xffff0000, v32
    v_lshlrev_b32 v66, 16, v33
    v_and_b32 v67, 0xffff0000, v33
    v_lshlrev_b32 v68, 16, v34
    v_and_b32 v69, 0xffff0000, v34
    v_lshlrev_b32 v86, 16, v44
    v_lshlrev_b32 v87, 16, v46
    v_and_b32 v88, 0xffff0000, v44
    v_and_b32 v89, 0xffff0000, v46
    v_lshlrev_b32 v90, 16, v45
    v_lshlrev_b32 v91, 16, v47
    v_and_b32 v92, 0xffff0000, v45
    v_and_b32 v93, 0xffff0000, v47

    v_mul_f32 v94, v48, v92
    v_mul_f32 v95, v49, v93
    v_cvt_pk_bf16_f32 v112, v94, v95
    v_lshlrev_b32 v94, 16, v112
    v_and_b32 v95, 0xffff0000, v112
    v_mul_f32 v110, v50, v90
    v_mul_f32 v111, v51, v91
    v_cvt_pk_bf16_f32 v112, v110, v111
    v_lshlrev_b32 v110, 16, v112
    v_and_b32 v111, 0xffff0000, v112
    v_add_f32 v94, v94, v110
    v_add_f32 v95, v95, v111
    v_cvt_pk_bf16_f32 v112, v94, v95
    v_lshlrev_b32 v94, 16, v112
    v_and_b32 v95, 0xffff0000, v112
    v_mul_f32 v110, v52, v88
    v_mul_f32 v111, v53, v89
    v_cvt_pk_bf16_f32 v112, v110, v111
    v_lshlrev_b32 v110, 16, v112
    v_and_b32 v111, 0xffff0000, v112
    v_add_f32 v94, v94, v110
    v_add_f32 v95, v95, v111
    v_cvt_pk_bf16_f32 v112, v94, v95
    v_lshlrev_b32 v94, 16, v112
    v_and_b32 v95, 0xffff0000, v112
    v_mul_f32 v110, v54, v86
    v_mul_f32 v111, v55, v87
    v_cvt_pk_bf16_f32 v112, v110, v111
    v_lshlrev_b32 v110, 16, v112
    v_and_b32 v111, 0xffff0000, v112
    v_add_f32 v94, v94, v110
    v_add_f32 v95, v95, v111
    v_cvt_pk_bf16_f32 v112, v94, v95
    v_lshlrev_b32 v94, 16, v112
    v_and_b32 v95, 0xffff0000, v112
    v_mul_f32 v96, v50, v92
    v_mul_f32 v97, v51, v93
    v_cvt_pk_bf16_f32 v112, v96, v97
    v_lshlrev_b32 v96, 16, v112
    v_and_b32 v97, 0xffff0000, v112
    v_mul_f32 v110, v52, v90
    v_mul_f32 v111, v53, v91
    v_cvt_pk_bf16_f32 v112, v110, v111
    v_lshlrev_b32 v110, 16, v112
    v_and_b32 v111, 0xffff0000, v112
    v_add_f32 v96, v96, v110
    v_add_f32 v97, v97, v111
    v_cvt_pk_bf16_f32 v112, v96, v97
    v_lshlrev_b32 v96, 16, v112
    v_and_b32 v97, 0xffff0000, v112
    v_mul_f32 v110, v54, v88
    v_mul_f32 v111, v55, v89
    v_cvt_pk_bf16_f32 v112, v110, v111
    v_lshlrev_b32 v110, 16, v112
    v_and_b32 v111, 0xffff0000, v112
    v_add_f32 v96, v96, v110
    v_add_f32 v97, v97, v111
    v_cvt_pk_bf16_f32 v112, v96, v97
    v_lshlrev_b32 v96, 16, v112
    v_and_b32 v97, 0xffff0000, v112
    v_mul_f32 v110, v56, v86
    v_mul_f32 v111, v57, v87
    v_cvt_pk_bf16_f32 v112, v110, v111
    v_lshlrev_b32 v110, 16, v112
    v_and_b32 v111, 0xffff0000, v112
    v_add_f32 v96, v96, v110
    v_add_f32 v97, v97, v111
    v_cvt_pk_bf16_f32 v112, v96, v97
    v_lshlrev_b32 v96, 16, v112
    v_and_b32 v97, 0xffff0000, v112
    v_mul_f32 v98, v52, v92
    v_mul_f32 v99, v53, v93
    v_cvt_pk_bf16_f32 v112, v98, v99
    v_lshlrev_b32 v98, 16, v112
    v_and_b32 v99, 0xffff0000, v112
    v_mul_f32 v110, v54, v90
    v_mul_f32 v111, v55, v91
    v_cvt_pk_bf16_f32 v112, v110, v111
    v_lshlrev_b32 v110, 16, v112
    v_and_b32 v111, 0xffff0000, v112
    v_add_f32 v98, v98, v110
    v_add_f32 v99, v99, v111
    v_cvt_pk_bf16_f32 v112, v98, v99
    v_lshlrev_b32 v98, 16, v112
    v_and_b32 v99, 0xffff0000, v112
    v_mul_f32 v110, v56, v88
    v_mul_f32 v111, v57, v89
    v_cvt_pk_bf16_f32 v112, v110, v111
    v_lshlrev_b32 v110, 16, v112
    v_and_b32 v111, 0xffff0000, v112
    v_add_f32 v98, v98, v110
    v_add_f32 v99, v99, v111
    v_cvt_pk_bf16_f32 v112, v98, v99
    v_lshlrev_b32 v98, 16, v112
    v_and_b32 v99, 0xffff0000, v112
    v_mul_f32 v110, v58, v86
    v_mul_f32 v111, v59, v87
    v_cvt_pk_bf16_f32 v112, v110, v111
    v_lshlrev_b32 v110, 16, v112
    v_and_b32 v111, 0xffff0000, v112
    v_add_f32 v98, v98, v110
    v_add_f32 v99, v99, v111
    v_cvt_pk_bf16_f32 v112, v98, v99
    v_lshlrev_b32 v98, 16, v112
    v_and_b32 v99, 0xffff0000, v112
    s_waitcnt vmcnt(0)
    s_barrier
    s_waitcnt vmcnt(0)
    v_mul_f32 v100, v54, v92
    v_mul_f32 v101, v55, v93
    v_cvt_pk_bf16_f32 v112, v100, v101
    v_lshlrev_b32 v100, 16, v112
    v_and_b32 v101, 0xffff0000, v112
    v_mul_f32 v110, v56, v90
    v_mul_f32 v111, v57, v91
    v_cvt_pk_bf16_f32 v112, v110, v111
    v_lshlrev_b32 v110, 16, v112
    v_and_b32 v111, 0xffff0000, v112
    v_add_f32 v100, v100, v110
    v_add_f32 v101, v101, v111
    v_cvt_pk_bf16_f32 v112, v100, v101
    v_lshlrev_b32 v100, 16, v112
    v_and_b32 v101, 0xffff0000, v112
    v_mul_f32 v110, v58, v88
    v_mul_f32 v111, v59, v89
    v_cvt_pk_bf16_f32 v112, v110, v111
    v_lshlrev_b32 v110, 16, v112
    v_and_b32 v111, 0xffff0000, v112
    v_add_f32 v100, v100, v110
    v_add_f32 v101, v101, v111
    v_cvt_pk_bf16_f32 v112, v100, v101
    v_lshlrev_b32 v100, 16, v112
    v_and_b32 v101, 0xffff0000, v112
    v_mul_f32 v110, v60, v86
    v_mul_f32 v111, v61, v87
    v_cvt_pk_bf16_f32 v112, v110, v111
    v_lshlrev_b32 v110, 16, v112
    v_and_b32 v111, 0xffff0000, v112
    v_add_f32 v100, v100, v110
    v_add_f32 v101, v101, v111
    v_cvt_pk_bf16_f32 v112, v100, v101
    v_lshlrev_b32 v100, 16, v112
    v_and_b32 v101, 0xffff0000, v112
    v_mul_f32 v102, v56, v92
    v_mul_f32 v103, v57, v93
    v_cvt_pk_bf16_f32 v112, v102, v103
    v_lshlrev_b32 v102, 16, v112
    v_and_b32 v103, 0xffff0000, v112
    v_mul_f32 v110, v58, v90
    v_mul_f32 v111, v59, v91
    v_cvt_pk_bf16_f32 v112, v110, v111
    v_lshlrev_b32 v110, 16, v112
    v_and_b32 v111, 0xffff0000, v112
    v_add_f32 v102, v102, v110
    v_add_f32 v103, v103, v111
    v_cvt_pk_bf16_f32 v112, v102, v103
    v_lshlrev_b32 v102, 16, v112
    v_and_b32 v103, 0xffff0000, v112
    v_mul_f32 v110, v60, v88
    v_mul_f32 v111, v61, v89
    v_cvt_pk_bf16_f32 v112, v110, v111
    v_lshlrev_b32 v110, 16, v112
    v_and_b32 v111, 0xffff0000, v112
    v_add_f32 v102, v102, v110
    v_add_f32 v103, v103, v111
    v_cvt_pk_bf16_f32 v112, v102, v103
    v_lshlrev_b32 v102, 16, v112
    v_and_b32 v103, 0xffff0000, v112
    v_mul_f32 v110, v62, v86
    v_mul_f32 v111, v63, v87
    v_cvt_pk_bf16_f32 v112, v110, v111
    v_lshlrev_b32 v110, 16, v112
    v_and_b32 v111, 0xffff0000, v112
    v_add_f32 v102, v102, v110
    v_add_f32 v103, v103, v111
    v_cvt_pk_bf16_f32 v112, v102, v103
    v_lshlrev_b32 v102, 16, v112
    v_and_b32 v103, 0xffff0000, v112
    v_mul_f32 v104, v58, v92
    v_mul_f32 v105, v59, v93
    v_cvt_pk_bf16_f32 v112, v104, v105
    v_lshlrev_b32 v104, 16, v112
    v_and_b32 v105, 0xffff0000, v112
    v_mul_f32 v110, v60, v90
    v_mul_f32 v111, v61, v91
    v_cvt_pk_bf16_f32 v112, v110, v111
    v_lshlrev_b32 v110, 16, v112
    v_and_b32 v111, 0xffff0000, v112
    v_add_f32 v104, v104, v110
    v_add_f32 v105, v105, v111
    v_cvt_pk_bf16_f32 v112, v104, v105
    v_lshlrev_b32 v104, 16, v112
    v_and_b32 v105, 0xffff0000, v112
    v_mul_f32 v110, v62, v88
    v_mul_f32 v111, v63, v89
    v_cvt_pk_bf16_f32 v112, v110, v111
    v_lshlrev_b32 v110, 16, v112
    v_and_b32 v111, 0xffff0000, v112
    v_add_f32 v104, v104, v110
    v_add_f32 v105, v105, v111
    v_cvt_pk_bf16_f32 v112, v104, v105
    v_lshlrev_b32 v104, 16, v112
    v_and_b32 v105, 0xffff0000, v112
    v_mul_f32 v110, v64, v86
    v_mul_f32 v111, v65, v87
    v_cvt_pk_bf16_f32 v112, v110, v111
    v_lshlrev_b32 v110, 16, v112
    v_and_b32 v111, 0xffff0000, v112
    v_add_f32 v104, v104, v110
    v_add_f32 v105, v105, v111
    v_cvt_pk_bf16_f32 v112, v104, v105
    v_lshlrev_b32 v104, 16, v112
    v_and_b32 v105, 0xffff0000, v112
    v_mul_f32 v106, v60, v92
    v_mul_f32 v107, v61, v93
    v_cvt_pk_bf16_f32 v112, v106, v107
    v_lshlrev_b32 v106, 16, v112
    v_and_b32 v107, 0xffff0000, v112
    v_mul_f32 v110, v62, v90
    v_mul_f32 v111, v63, v91
    v_cvt_pk_bf16_f32 v112, v110, v111
    v_lshlrev_b32 v110, 16, v112
    v_and_b32 v111, 0xffff0000, v112
    v_add_f32 v106, v106, v110
    v_add_f32 v107, v107, v111
    v_cvt_pk_bf16_f32 v112, v106, v107
    v_lshlrev_b32 v106, 16, v112
    v_and_b32 v107, 0xffff0000, v112
    v_mul_f32 v110, v64, v88
    v_mul_f32 v111, v65, v89
    v_cvt_pk_bf16_f32 v112, v110, v111
    v_lshlrev_b32 v110, 16, v112
    v_and_b32 v111, 0xffff0000, v112
    v_add_f32 v106, v106, v110
    v_add_f32 v107, v107, v111
    v_cvt_pk_bf16_f32 v112, v106, v107
    v_lshlrev_b32 v106, 16, v112
    v_and_b32 v107, 0xffff0000, v112
    v_mul_f32 v110, v66, v86
    v_mul_f32 v111, v67, v87
    v_cvt_pk_bf16_f32 v112, v110, v111
    v_lshlrev_b32 v110, 16, v112
    v_and_b32 v111, 0xffff0000, v112
    v_add_f32 v106, v106, v110
    v_add_f32 v107, v107, v111
    v_cvt_pk_bf16_f32 v112, v106, v107
    v_lshlrev_b32 v106, 16, v112
    v_and_b32 v107, 0xffff0000, v112
    v_mul_f32 v108, v62, v92
    v_mul_f32 v109, v63, v93
    v_cvt_pk_bf16_f32 v112, v108, v109
    v_lshlrev_b32 v108, 16, v112
    v_and_b32 v109, 0xffff0000, v112
    v_mul_f32 v110, v64, v90
    v_mul_f32 v111, v65, v91
    v_cvt_pk_bf16_f32 v112, v110, v111
    v_lshlrev_b32 v110, 16, v112
    v_and_b32 v111, 0xffff0000, v112
    v_add_f32 v108, v108, v110
    v_add_f32 v109, v109, v111
    v_cvt_pk_bf16_f32 v112, v108, v109
    v_lshlrev_b32 v108, 16, v112
    v_and_b32 v109, 0xffff0000, v112
    v_mul_f32 v110, v66, v88
    v_mul_f32 v111, v67, v89
    v_cvt_pk_bf16_f32 v112, v110, v111
    v_lshlrev_b32 v110, 16, v112
    v_and_b32 v111, 0xffff0000, v112
    v_add_f32 v108, v108, v110
    v_add_f32 v109, v109, v111
    v_cvt_pk_bf16_f32 v112, v108, v109
    v_lshlrev_b32 v108, 16, v112
    v_and_b32 v109, 0xffff0000, v112
    v_mul_f32 v110, v68, v86
    v_mul_f32 v111, v69, v87
    v_cvt_pk_bf16_f32 v112, v110, v111
    v_lshlrev_b32 v110, 16, v112
    v_and_b32 v111, 0xffff0000, v112
    v_add_f32 v108, v108, v110
    v_add_f32 v109, v109, v111
    v_cvt_pk_bf16_f32 v112, v108, v109
    v_lshlrev_b32 v108, 16, v112
    v_and_b32 v109, 0xffff0000, v112
    s_barrier
    v_lshlrev_b32 v70, 16, v35
    v_and_b32 v71, 0xffff0000, v35
    v_lshlrev_b32 v72, 16, v36
    v_and_b32 v73, 0xffff0000, v36
    v_lshlrev_b32 v74, 16, v37
    v_and_b32 v75, 0xffff0000, v37
    v_lshlrev_b32 v76, 16, v38
    v_and_b32 v77, 0xffff0000, v38
    v_lshlrev_b32 v78, 16, v39
    v_and_b32 v79, 0xffff0000, v39
    v_lshlrev_b32 v80, 16, v40
    v_and_b32 v81, 0xffff0000, v40
    v_lshlrev_b32 v82, 16, v41
    v_and_b32 v83, 0xffff0000, v41
    v_lshlrev_b32 v84, 16, v42
    v_and_b32 v85, 0xffff0000, v42
    v_pk_mul_f32 v[94:95], v[94:95], v[70:71]
    v_pk_mul_f32 v[96:97], v[96:97], v[72:73]
    v_pk_mul_f32 v[98:99], v[98:99], v[74:75]
    v_pk_mul_f32 v[100:101], v[100:101], v[76:77]
    v_pk_mul_f32 v[102:103], v[102:103], v[78:79]
    v_pk_mul_f32 v[104:105], v[104:105], v[80:81]
    v_pk_mul_f32 v[106:107], v[106:107], v[82:83]
    v_pk_mul_f32 v[108:109], v[108:109], v[84:85]
    v_cvt_pk_bf16_f32 v24, v108, v106
    v_cvt_pk_bf16_f32 v28, v109, v107
    v_cvt_pk_bf16_f32 v25, v104, v102
    v_cvt_pk_bf16_f32 v29, v105, v103
    v_cvt_pk_bf16_f32 v26, v100, v98
    v_cvt_pk_bf16_f32 v30, v101, v99
    v_cvt_pk_bf16_f32 v27, v96, v94
    v_cvt_pk_bf16_f32 v31, v97, v95
    s_lshl_b32 s46, s47, 18
    s_add_u32 s46, s46, 0x1800000
    s_lshr_b32 s48, s2, 3
    s_lshl_b32 s48, s48, 5
    s_add_u32 s46, s46, s48
    s_lshr_b32 s48, s39, 1
    s_lshl_b32 s48, s48, 4
    s_add_u32 s46, s46, s48
    s_and_b32 s48, s39, 1
    s_lshl_b32 s48, s48, 11
    s_add_u32 s46, s46, s48
    v_lshlrev_b32 v5, 13, v4
    v_lshl_add_u32 v5, v3, 10, v5
    v_add_u32 v6, 0x1000, v5
    buffer_store_dwordx4 v[24:27], v5, s[24:27], s46 offen
    buffer_store_dwordx4 v[28:31], v6, s[24:27], s46 offen

    s_xor_b32 s51, s40, 7
    s_or_b32 s51, s51, s2
    s_cmp_lg_u32 s51, 0
    s_cbranch_scc1 qkv1_kernel_ne
    v_mov_b32 v20, 0
    s_mov_b32 s53, 0x1562000
    buffer_load_dword v21, v20, s[24:27], s53 offen sc1
    s_waitcnt vmcnt(0)
    v_add_u32 v21, 2, v21
    v_max_u32 v21, 2, v21
    v_subrev_u32 v21, 1, v21
    s_mov_b64 exec, 1
    buffer_store_dword v21, v20, s[24:27], s53 offen
    s_mov_b64 exec, -1

qkv1_kernel_ne:
    s_endpgm
.globl mega_kernel
.p2align 8
.type mega_kernel,@function
mega_kernel:
    s_cmp_ge_u32 s2, 256
    s_cbranch_scc1 mega_done
    s_load_dwordx4 s[4:7], s[0:1], 0
    s_load_dwordx2 s[18:19], s[0:1], 16
    s_load_dwordx2 s[8:9], s[0:1], 72
    s_load_dwordx2 s[10:11], s[0:1], 48
    s_load_dwordx2 s[12:13], s[0:1], 64
    s_load_dwordx2 s[14:15], s[0:1], 88
    s_load_dwordx2 s[16:17], s[0:1], 56
    s_load_dwordx4 s[28:31], s[0:1], 32
    v_lshrrev_b32 v2, 6, v0
    v_and_b32 v1, 63, v0
    v_readfirstlane_b32 s40, v2
    v_lshlrev_b32 v3, 4, v1
    v_lshlrev_b32 v2, 2, v1
    s_mov_b32 s3, 0
    s_and_b32 s36, s2, 7
    s_lshr_b32 s37, s2, 3
    s_mov_b32 s67, 0xfffffffe
    s_waitcnt lgkmcnt(0)

    s_mov_b32 s24, s14
    s_mov_b32 s25, s15
    s_mov_b32 s26, 0x2600000
    s_mov_b32 s27, 0x00020000
    s_mov_b32 s64, 0x1562000
    s_load_dword s65, s[14:15], s64
    s_mov_b32 s34, s6
    s_mov_b32 s35, s7
    s_mov_b32 s6, s18
    s_mov_b32 s7, s19
mega_layer:
    s_lshl_b32 s41, s36, 2
    s_and_b32 s46, s37, 3
    s_add_u32 s41, s41, s46

    s_mul_i32 s38, s3, 0x600000
    s_lshl_b32 s48, s41, 16
    s_add_u32 s48, s48, s38

mega_a_go:
    s_cmp_ge_u32 s40, 8
    s_cbranch_scc1 mega_help
    s_lshr_b32 s42, s37, 2
    s_and_b32 s43, s40, 3
    s_lshr_b32 s47, s40, 2
    s_lshl_b32 s42, s42, 3
    s_lshl_b32 s46, s43, 1
    s_add_u32 s42, s42, s46
    s_lshl_b32 s49, s42, 10
    s_add_u32 s49, s49, s48
    s_lshl_b32 s50, s47, 5
    s_add_u32 s51, s50, s43
    s_lshl_b32 s51, s51, 10
    s_add_u32 s52, s48, s51
    s_add_u32 s53, s52, 0x200000
    s_add_u32 s54, s52, 0x201000
    s_add_u32 s55, s52, 0x400000
    s_add_u32 s58, s52, 0x401000

    s_cmp_lg_u32 s3, 0
    s_cbranch_scc1 mega_a_h1
    s_lshr_b32 s59, s41, 1
    s_lshl_b32 s59, s59, 8
    s_add_u32 s59, s59, 0x1566000

    s_branch mega_a_nh
mega_a_h1:
    s_add_u32 s59, s49, 1024
    v_writelane_b32 v14, s55, 0
    v_writelane_b32 v14, s58, 1
    v_writelane_b32 v14, s49, 2
    v_writelane_b32 v14, s59, 3
    s_movk_i32 s59, 1020

    s_mov_b32 s69, 0x8000
mega_hw_34:
    s_mov_b64 exec, 0xf
    buffer_load_dword v15, v14, s[24:27], s59 offen sc1
    s_waitcnt vmcnt(0)
    v_cmp_eq_u32 vcc, -1, v15
    s_mov_b64 exec, -1
    s_bcnt1_i32_b64 s66, vcc
    s_cmp_le_u32 s66, 1
    s_cbranch_scc1 mega_hw_34_d
    s_sub_u32 s69, s69, 1
    s_cbranch_scc1 mega_hw_34_d

    s_sleep 1
    s_branch mega_hw_34

mega_hw_34_d:
mega_a_nh:
    buffer_load_dwordx4 v[16:19], v3, s[24:27], s53 offen sc1
    buffer_load_dwordx4 v[20:23], v3, s[24:27], s55 offen sc1
    buffer_load_dwordx4 v[4:7], v3, s[24:27], s49 offen sc1
    buffer_load_dwordx4 v[8:11], v3, s[24:27], s49 offen offset:1024 sc1
    buffer_load_dwordx4 v[24:27], v3, s[24:27], s54 offen sc1
    buffer_load_dwordx4 v[28:31], v3, s[24:27], s58 offen sc1
    v_mov_b32 v48, 0
    v_mov_b32 v64, 0
    v_mov_b32 v49, 0
    v_mov_b32 v65, 0
    v_mov_b32 v50, 0
    v_mov_b32 v66, 0
    v_mov_b32 v51, 0
    v_mov_b32 v67, 0
    v_mov_b32 v52, 0
    v_mov_b32 v68, 0
    v_mov_b32 v53, 0
    v_mov_b32 v69, 0
    v_mov_b32 v54, 0
    v_mov_b32 v70, 0
    v_mov_b32 v55, 0
    v_mov_b32 v71, 0
    v_mov_b32 v56, 0
    v_mov_b32 v72, 0
    v_mov_b32 v57, 0
    v_mov_b32 v73, 0
    v_mov_b32 v58, 0
    v_mov_b32 v74, 0
    v_mov_b32 v59, 0
    v_mov_b32 v75, 0
    v_mov_b32 v60, 0
    v_mov_b32 v76, 0
    v_mov_b32 v61, 0
    v_mov_b32 v77, 0
    v_mov_b32 v62, 0
    v_mov_b32 v78, 0
    v_mov_b32 v63, 0
    v_mov_b32 v79, 0
    v_and_b32 v14, 27, v1
    v_cmp_eq_u32 vcc, 16, v14
    v_mov_b32 v15, 0x3f803f80
    s_lshl_b32 s59, s50, 10
    v_cndmask_b32 v14, 0, v15, vcc

    v_mov_b32 v96, v14
    v_mov_b32 v97, v14
    v_mov_b32 v98, v14
    v_mov_b32 v99, v14
    v_mov_b32 v100, v14
    v_mov_b32 v101, v14
    v_mov_b32 v102, v14
    v_mov_b32 v103, v14
    v_mov_b32 v104, v14
    v_mov_b32 v105, v14
    v_mov_b32 v106, v14
    v_mov_b32 v107, v14
    v_mov_b32 v108, v14
    v_mov_b32 v109, v14
    v_mov_b32 v110, v14
    v_mov_b32 v111, v14
    v_mov_b32 v84, 0
    v_mov_b32 v85, 0
    v_mov_b32 v86, 0
    v_mov_b32 v87, 0
    v_add_u32 v12, s59, v3
    v_and_b32 v13, 15, v1
    v_lshlrev_b32 v13, 4, v13
    v_lshrrev_b32 v14, 5, v1
    v_lshl_add_u32 v13, v14, 8, v13
    s_add_u32 s59, s59, 0x10000
    v_add_u32 v13, s59, v13
    s_mov_b32 s56, 0xffff
    s_mov_b32 s57, 0xffff
    v_add_u32 v32, s51, v3
    v_add_u32 v33, 0x10000, v32

    s_mov_b32 s69, 0x8000
    s_mov_b32 s66, 0x3f
    s_waitcnt vmcnt(0)
    v_max3_u32 v15, v16, v17, v18
    v_max3_u32 v15, v15, v19, v20
    v_max3_u32 v15, v15, v21, v22
    v_max3_u32 v15, v15, v23, v4
    v_max3_u32 v15, v15, v5, v6
    v_max3_u32 v15, v15, v7, v8
    v_max3_u32 v15, v15, v9, v10
    v_max3_u32 v15, v15, v11, v24
    v_max3_u32 v15, v15, v25, v26
    v_max3_u32 v15, v15, v27, v28
    v_max3_u32 v15, v15, v29, v30
    v_max_u32 v15, v15, v31
    v_cmp_eq_u32 vcc, -1, v15
    s_cmp_eq_u64 vcc, 0
    s_cbranch_scc0 mega_cu_35_c

    ds_write_b128 v32, v[16:19]
    ds_write_b128 v33, v[20:23]
    ds_write_b128 v32, v[24:27] offset:4096
    ds_write_b128 v33, v[28:31] offset:4096
    s_branch mega_cu_35_d
mega_cu_35:
    s_bitcmp1_b32 s66, 0
    s_cbranch_scc0 mega_cu_35_l0
    buffer_load_dwordx4 v[16:19], v3, s[24:27], s53 offen sc1
mega_cu_35_l0:
    s_bitcmp1_b32 s66, 1
    s_cbranch_scc0 mega_cu_35_l1
    buffer_load_dwordx4 v[20:23], v3, s[24:27], s55 offen sc1
mega_cu_35_l1:
    s_bitcmp1_b32 s66, 2
    s_cbranch_scc0 mega_cu_35_l2
    buffer_load_dwordx4 v[4:7], v3, s[24:27], s49 offen sc1
mega_cu_35_l2:
    s_bitcmp1_b32 s66, 3
    s_cbranch_scc0 mega_cu_35_l3
    buffer_load_dwordx4 v[8:11], v3, s[24:27], s49 offen offset:1024 sc1
mega_cu_35_l3:
    s_bitcmp1_b32 s66, 4
    s_cbranch_scc0 mega_cu_35_l4
    buffer_load_dwordx4 v[24:27], v3, s[24:27], s54 offen sc1
mega_cu_35_l4:
    s_bitcmp1_b32 s66, 5
    s_cbranch_scc0 mega_cu_35_l5
    buffer_load_dwordx4 v[28:31], v3, s[24:27], s58 offen sc1
mega_cu_35_l5:
    s_waitcnt vmcnt(0)
mega_cu_35_c:
    s_bitcmp1_b32 s66, 0
    s_cbranch_scc0 mega_cu_35_k0
    v_max3_u32 v15, v16, v17, v18
    v_max_u32 v15, v15, v19
    v_cmp_eq_u32 vcc, -1, v15
    s_cmp_eq_u64 vcc, 0
    s_cbranch_scc0 mega_cu_35_k0
    s_bitset0_b32 s66, 0

    ds_write_b128 v32, v[16:19]
mega_cu_35_k0:
    s_bitcmp1_b32 s66, 1
    s_cbranch_scc0 mega_cu_35_k1
    v_max3_u32 v15, v20, v21, v22
    v_max_u32 v15, v15, v23
    v_cmp_eq_u32 vcc, -1, v15
    s_cmp_eq_u64 vcc, 0
    s_cbranch_scc0 mega_cu_35_k1
    s_bitset0_b32 s66, 1

    ds_write_b128 v33, v[20:23]
mega_cu_35_k1:
    s_bitcmp1_b32 s66, 2
    s_cbranch_scc0 mega_cu_35_k2
    v_max3_u32 v15, v4, v5, v6
    v_max_u32 v15, v15, v7
    v_cmp_eq_u32 vcc, -1, v15
    s_cmp_eq_u64 vcc, 0
    s_cbranch_scc0 mega_cu_35_k2
    s_bitset0_b32 s66, 2

mega_cu_35_k2:
    s_bitcmp1_b32 s66, 3
    s_cbranch_scc0 mega_cu_35_k3
    v_max3_u32 v15, v8, v9, v10
    v_max_u32 v15, v15, v11
    v_cmp_eq_u32 vcc, -1, v15
    s_cmp_eq_u64 vcc, 0
    s_cbranch_scc0 mega_cu_35_k3
    s_bitset0_b32 s66, 3

mega_cu_35_k3:
    s_bitcmp1_b32 s66, 4
    s_cbranch_scc0 mega_cu_35_k4
    v_max3_u32 v15, v24, v25, v26
    v_max_u32 v15, v15, v27
    v_cmp_eq_u32 vcc, -1, v15
    s_cmp_eq_u64 vcc, 0
    s_cbranch_scc0 mega_cu_35_k4
    s_bitset0_b32 s66, 4

    ds_write_b128 v32, v[24:27] offset:4096
mega_cu_35_k4:
    s_bitcmp1_b32 s66, 5
    s_cbranch_scc0 mega_cu_35_k5
    v_max3_u32 v15, v28, v29, v30
    v_max_u32 v15, v15, v31
    v_cmp_eq_u32 vcc, -1, v15
    s_cmp_eq_u64 vcc, 0
    s_cbranch_scc0 mega_cu_35_k5
    s_bitset0_b32 s66, 5

    ds_write_b128 v33, v[28:31] offset:4096
mega_cu_35_k5:
    s_cmp_eq_u32 s66, 0
    s_cbranch_scc1 mega_cu_35_d
    s_sub_u32 s69, s69, 1
    s_cbranch_scc1 mega_cu_35_d

    s_sleep 1
    s_branch mega_cu_35

mega_cu_35_d:
    v_mov_b32 v14, 160004
    v_mov_b32 v112, 1
    s_waitcnt lgkmcnt(0)
    s_barrier

    ds_read_b128 v[88:91], v12 offset:0
    s_mov_b64 exec, s[56:57]
    ds_read_b128 v[96:99], v13 offset:0
    ds_read_b128 v[100:103], v13 offset:512
    s_mov_b64 exec, -1
    s_waitcnt lgkmcnt(2)
    v_mfma_f32_32x32x16_bf16 v[16:31], v[88:91], v[4:7], 0
    s_waitcnt lgkmcnt(0)
    s_mov_b32 s58, 4
    s_mov_b32 s59, 0
    s_nop 7
    s_nop 1

mega_loop:
    s_cmp_eq_u32 s47, 0
    s_cbranch_scc1 mega_pr_36
    s_setprio 1
mega_pr_36:
    v_exp_f32 v16, v16
    v_exp_f32 v17, v17
    v_mfma_f32_32x32x16_bf16 v[64:79], v[108:111], v[84:87], v[64:79]
    v_exp_f32 v18, v18
    v_cvt_pk_bf16_f32 v80, v16, v17
    v_exp_f32 v19, v19
    v_exp_f32 v20, v20
    v_cvt_pk_bf16_f32 v81, v18, v19
    v_exp_f32 v21, v21
    v_mfma_f32_32x32x16_bf16 v[32:47], v[88:91], v[8:11], 0
    ds_read_b128 v[92:95], v12 offset:1024
    s_mov_b64 exec, s[56:57]
    ds_read_b128 v[104:107], v13 offset:1024
    ds_read_b128 v[108:111], v13 offset:1536
    s_mov_b64 exec, -1
    v_exp_f32 v22, v22
    v_cvt_pk_bf16_f32 v82, v20, v21
    v_exp_f32 v23, v23
    v_exp_f32 v24, v24
    v_cvt_pk_bf16_f32 v83, v22, v23
    v_exp_f32 v25, v25
    v_exp_f32 v26, v26
    v_mfma_f32_32x32x16_bf16 v[48:63], v[96:99], v[80:83], v[48:63]
    v_cvt_pk_bf16_f32 v84, v24, v25
    v_exp_f32 v27, v27
    v_exp_f32 v28, v28
    v_cvt_pk_bf16_f32 v85, v26, v27
    v_exp_f32 v29, v29
    v_exp_f32 v30, v30
    v_cvt_pk_bf16_f32 v86, v28, v29
    v_exp_f32 v31, v31
    s_nop 0
    v_cvt_pk_bf16_f32 v87, v30, v31
    v_exp_f32 v32, v32
    v_exp_f32 v33, v33
    v_mfma_f32_32x32x16_bf16 v[48:63], v[100:103], v[84:87], v[48:63]
    v_exp_f32 v34, v34
    v_cvt_pk_bf16_f32 v80, v32, v33
    v_exp_f32 v35, v35
    v_exp_f32 v36, v36
    v_cvt_pk_bf16_f32 v81, v34, v35
    v_exp_f32 v37, v37
    s_waitcnt lgkmcnt(2)
    v_mfma_f32_32x32x16_bf16 v[16:31], v[92:95], v[4:7], 0
    v_exp_f32 v38, v38
    v_cvt_pk_bf16_f32 v82, v36, v37
    v_exp_f32 v39, v39
    v_exp_f32 v40, v40
    v_cvt_pk_bf16_f32 v83, v38, v39
    v_exp_f32 v41, v41
    v_exp_f32 v42, v42
    v_mfma_f32_32x32x16_bf16 v[64:79], v[96:99], v[80:83], v[64:79]
    v_cvt_pk_bf16_f32 v84, v40, v41
    v_exp_f32 v43, v43
    v_exp_f32 v44, v44
    v_cvt_pk_bf16_f32 v85, v42, v43
    v_exp_f32 v45, v45
    v_exp_f32 v46, v46
    v_cvt_pk_bf16_f32 v86, v44, v45
    v_exp_f32 v47, v47
    s_waitcnt lgkmcnt(0)
    v_cvt_pk_bf16_f32 v87, v46, v47
    v_exp_f32 v16, v16
    v_exp_f32 v17, v17
    v_mfma_f32_32x32x16_bf16 v[64:79], v[100:103], v[84:87], v[64:79]
    v_exp_f32 v18, v18
    v_cvt_pk_bf16_f32 v80, v16, v17
    v_exp_f32 v19, v19
    v_exp_f32 v20, v20
    v_cvt_pk_bf16_f32 v81, v18, v19
    v_exp_f32 v21, v21
    v_mfma_f32_32x32x16_bf16 v[32:47], v[92:95], v[8:11], 0
    ds_read_b128 v[88:91], v12 offset:2048
    s_mov_b64 exec, s[56:57]
    ds_read_b128 v[96:99], v13 offset:2048
    ds_read_b128 v[100:103], v13 offset:2560
    s_mov_b64 exec, -1
    v_exp_f32 v22, v22
    v_cvt_pk_bf16_f32 v82, v20, v21
    v_exp_f32 v23, v23
    v_exp_f32 v24, v24
    v_cvt_pk_bf16_f32 v83, v22, v23
    v_exp_f32 v25, v25
    v_exp_f32 v26, v26
    v_mfma_f32_32x32x16_bf16 v[48:63], v[104:107], v[80:83], v[48:63]
    v_cvt_pk_bf16_f32 v84, v24, v25
    v_exp_f32 v27, v27
    v_exp_f32 v28, v28
    v_cvt_pk_bf16_f32 v85, v26, v27
    v_exp_f32 v29, v29
    v_exp_f32 v30, v30
    v_cvt_pk_bf16_f32 v86, v28, v29
    v_exp_f32 v31, v31
    s_nop 0
    v_cvt_pk_bf16_f32 v87, v30, v31
    v_exp_f32 v32, v32
    v_exp_f32 v33, v33
    v_mfma_f32_32x32x16_bf16 v[48:63], v[108:111], v[84:87], v[48:63]
    v_exp_f32 v34, v34
    v_cvt_pk_bf16_f32 v80, v32, v33
    v_exp_f32 v35, v35
    v_exp_f32 v36, v36
    v_cvt_pk_bf16_f32 v81, v34, v35
    v_exp_f32 v37, v37
    s_waitcnt lgkmcnt(2)
    v_mfma_f32_32x32x16_bf16 v[16:31], v[88:91], v[4:7], 0
    v_exp_f32 v38, v38
    v_cvt_pk_bf16_f32 v82, v36, v37
    v_exp_f32 v39, v39
    v_exp_f32 v40, v40
    v_cvt_pk_bf16_f32 v83, v38, v39
    v_exp_f32 v41, v41
    v_exp_f32 v42, v42
    v_mfma_f32_32x32x16_bf16 v[64:79], v[104:107], v[80:83], v[64:79]
    v_cvt_pk_bf16_f32 v84, v40, v41
    v_exp_f32 v43, v43
    v_exp_f32 v44, v44
    v_cvt_pk_bf16_f32 v85, v42, v43
    v_exp_f32 v45, v45
    v_exp_f32 v46, v46
    v_cvt_pk_bf16_f32 v86, v44, v45
    v_exp_f32 v47, v47
    s_waitcnt lgkmcnt(0)
    v_cvt_pk_bf16_f32 v87, v46, v47
    v_exp_f32 v16, v16
    v_exp_f32 v17, v17
    v_mfma_f32_32x32x16_bf16 v[64:79], v[108:111], v[84:87], v[64:79]
    v_exp_f32 v18, v18
    v_cvt_pk_bf16_f32 v80, v16, v17
    v_exp_f32 v19, v19
    v_exp_f32 v20, v20
    v_cvt_pk_bf16_f32 v81, v18, v19
    v_exp_f32 v21, v21
    v_mfma_f32_32x32x16_bf16 v[32:47], v[88:91], v[8:11], 0
    ds_read_b128 v[92:95], v12 offset:3072
    s_mov_b64 exec, s[56:57]
    ds_read_b128 v[104:107], v13 offset:3072
    ds_read_b128 v[108:111], v13 offset:3584
    s_mov_b64 exec, -1
    v_exp_f32 v22, v22
    v_cvt_pk_bf16_f32 v82, v20, v21
    v_exp_f32 v23, v23
    v_exp_f32 v24, v24
    v_cvt_pk_bf16_f32 v83, v22, v23
    v_exp_f32 v25, v25
    v_exp_f32 v26, v26
    v_mfma_f32_32x32x16_bf16 v[48:63], v[96:99], v[80:83], v[48:63]
    v_cvt_pk_bf16_f32 v84, v24, v25
    v_exp_f32 v27, v27
    v_exp_f32 v28, v28
    v_cvt_pk_bf16_f32 v85, v26, v27
    v_exp_f32 v29, v29
    v_exp_f32 v30, v30
    v_cvt_pk_bf16_f32 v86, v28, v29
    v_exp_f32 v31, v31
    s_nop 0
    v_cvt_pk_bf16_f32 v87, v30, v31
    v_exp_f32 v32, v32
    v_exp_f32 v33, v33
    v_mfma_f32_32x32x16_bf16 v[48:63], v[100:103], v[84:87], v[48:63]
    v_exp_f32 v34, v34
    v_cvt_pk_bf16_f32 v80, v32, v33
    v_exp_f32 v35, v35
    v_exp_f32 v36, v36
    v_cvt_pk_bf16_f32 v81, v34, v35
    v_exp_f32 v37, v37
    s_waitcnt lgkmcnt(2)
    v_mfma_f32_32x32x16_bf16 v[16:31], v[92:95], v[4:7], 0
    v_exp_f32 v38, v38
    v_cvt_pk_bf16_f32 v82, v36, v37
    v_exp_f32 v39, v39
    v_exp_f32 v40, v40
    v_cvt_pk_bf16_f32 v83, v38, v39
    v_exp_f32 v41, v41
    v_exp_f32 v42, v42
    v_mfma_f32_32x32x16_bf16 v[64:79], v[96:99], v[80:83], v[64:79]
    v_cvt_pk_bf16_f32 v84, v40, v41
    v_exp_f32 v43, v43
    v_exp_f32 v44, v44
    v_cvt_pk_bf16_f32 v85, v42, v43
    v_exp_f32 v45, v45
    v_exp_f32 v46, v46
    v_cvt_pk_bf16_f32 v86, v44, v45
    v_exp_f32 v47, v47
    s_waitcnt lgkmcnt(0)
    v_cvt_pk_bf16_f32 v87, v46, v47
    v_exp_f32 v16, v16
    v_exp_f32 v17, v17
    v_mfma_f32_32x32x16_bf16 v[64:79], v[100:103], v[84:87], v[64:79]
    v_exp_f32 v18, v18
    v_cvt_pk_bf16_f32 v80, v16, v17
    v_exp_f32 v19, v19
    v_exp_f32 v20, v20
    v_cvt_pk_bf16_f32 v81, v18, v19
    v_exp_f32 v21, v21
    v_mfma_f32_32x32x16_bf16 v[32:47], v[92:95], v[8:11], 0
    ds_read_b128 v[88:91], v12 offset:4096
    s_mov_b64 exec, s[56:57]
    ds_read_b128 v[96:99], v13 offset:4096
    ds_read_b128 v[100:103], v13 offset:4608
    s_mov_b64 exec, -1
    v_exp_f32 v22, v22
    v_cvt_pk_bf16_f32 v82, v20, v21
    v_exp_f32 v23, v23
    v_exp_f32 v24, v24
    v_cvt_pk_bf16_f32 v83, v22, v23
    v_exp_f32 v25, v25
    v_exp_f32 v26, v26
    v_mfma_f32_32x32x16_bf16 v[48:63], v[104:107], v[80:83], v[48:63]
    v_cvt_pk_bf16_f32 v84, v24, v25
    v_exp_f32 v27, v27
    v_exp_f32 v28, v28
    v_cvt_pk_bf16_f32 v85, v26, v27
    v_exp_f32 v29, v29
    v_exp_f32 v30, v30
    v_cvt_pk_bf16_f32 v86, v28, v29
    v_exp_f32 v31, v31
    s_nop 0
    v_cvt_pk_bf16_f32 v87, v30, v31
    v_exp_f32 v32, v32
    v_exp_f32 v33, v33
    v_mfma_f32_32x32x16_bf16 v[48:63], v[108:111], v[84:87], v[48:63]
    v_exp_f32 v34, v34
    v_cvt_pk_bf16_f32 v80, v32, v33
    v_exp_f32 v35, v35
    v_exp_f32 v36, v36
    v_cvt_pk_bf16_f32 v81, v34, v35
    v_exp_f32 v37, v37
    s_waitcnt lgkmcnt(2)
    v_mfma_f32_32x32x16_bf16 v[16:31], v[88:91], v[4:7], 0
    v_exp_f32 v38, v38
    v_cvt_pk_bf16_f32 v82, v36, v37
    v_exp_f32 v39, v39
    v_exp_f32 v40, v40
    v_cvt_pk_bf16_f32 v83, v38, v39
    v_exp_f32 v41, v41
    v_exp_f32 v42, v42
    v_mfma_f32_32x32x16_bf16 v[64:79], v[104:107], v[80:83], v[64:79]
    v_cvt_pk_bf16_f32 v84, v40, v41
    v_exp_f32 v43, v43
    v_exp_f32 v44, v44
    v_cvt_pk_bf16_f32 v85, v42, v43
    v_exp_f32 v45, v45
    v_exp_f32 v46, v46
    v_cvt_pk_bf16_f32 v86, v44, v45
    v_exp_f32 v47, v47
    s_waitcnt lgkmcnt(0)
    v_cvt_pk_bf16_f32 v87, v46, v47
    v_exp_f32 v16, v16
    v_exp_f32 v17, v17
    v_mfma_f32_32x32x16_bf16 v[64:79], v[108:111], v[84:87], v[64:79]
    v_exp_f32 v18, v18
    v_cvt_pk_bf16_f32 v80, v16, v17
    v_exp_f32 v19, v19
    v_exp_f32 v20, v20
    v_cvt_pk_bf16_f32 v81, v18, v19
    v_exp_f32 v21, v21
    v_mfma_f32_32x32x16_bf16 v[32:47], v[88:91], v[8:11], 0
    ds_read_b128 v[92:95], v12 offset:5120
    s_mov_b64 exec, s[56:57]
    ds_read_b128 v[104:107], v13 offset:5120
    ds_read_b128 v[108:111], v13 offset:5632
    s_mov_b64 exec, -1
    v_exp_f32 v22, v22
    v_cvt_pk_bf16_f32 v82, v20, v21
    v_exp_f32 v23, v23
    v_exp_f32 v24, v24
    v_cvt_pk_bf16_f32 v83, v22, v23
    v_exp_f32 v25, v25
    v_exp_f32 v26, v26
    v_mfma_f32_32x32x16_bf16 v[48:63], v[96:99], v[80:83], v[48:63]
    v_cvt_pk_bf16_f32 v84, v24, v25
    v_exp_f32 v27, v27
    v_exp_f32 v28, v28
    v_cvt_pk_bf16_f32 v85, v26, v27
    v_exp_f32 v29, v29
    v_exp_f32 v30, v30
    v_cvt_pk_bf16_f32 v86, v28, v29
    v_exp_f32 v31, v31
    s_nop 0
    v_cvt_pk_bf16_f32 v87, v30, v31
    v_exp_f32 v32, v32
    v_exp_f32 v33, v33
    v_mfma_f32_32x32x16_bf16 v[48:63], v[100:103], v[84:87], v[48:63]
    v_exp_f32 v34, v34
    v_cvt_pk_bf16_f32 v80, v32, v33
    v_exp_f32 v35, v35
    v_exp_f32 v36, v36
    v_cvt_pk_bf16_f32 v81, v34, v35
    v_exp_f32 v37, v37
    s_waitcnt lgkmcnt(2)
    v_mfma_f32_32x32x16_bf16 v[16:31], v[92:95], v[4:7], 0
    v_exp_f32 v38, v38
    v_cvt_pk_bf16_f32 v82, v36, v37
    v_exp_f32 v39, v39
    v_exp_f32 v40, v40
    v_cvt_pk_bf16_f32 v83, v38, v39
    v_exp_f32 v41, v41
    v_exp_f32 v42, v42
    v_mfma_f32_32x32x16_bf16 v[64:79], v[96:99], v[80:83], v[64:79]
    v_cvt_pk_bf16_f32 v84, v40, v41
    v_exp_f32 v43, v43
    v_exp_f32 v44, v44
    v_cvt_pk_bf16_f32 v85, v42, v43
    v_exp_f32 v45, v45
    v_exp_f32 v46, v46
    v_cvt_pk_bf16_f32 v86, v44, v45
    v_exp_f32 v47, v47
    s_waitcnt lgkmcnt(0)
    v_cvt_pk_bf16_f32 v87, v46, v47
    v_exp_f32 v16, v16
    v_exp_f32 v17, v17
    v_mfma_f32_32x32x16_bf16 v[64:79], v[100:103], v[84:87], v[64:79]
    v_exp_f32 v18, v18
    v_cvt_pk_bf16_f32 v80, v16, v17
    v_exp_f32 v19, v19
    v_exp_f32 v20, v20
    v_cvt_pk_bf16_f32 v81, v18, v19
    v_exp_f32 v21, v21
    v_mfma_f32_32x32x16_bf16 v[32:47], v[92:95], v[8:11], 0
    ds_read_b128 v[88:91], v12 offset:6144
    s_mov_b64 exec, s[56:57]
    ds_read_b128 v[96:99], v13 offset:6144
    ds_read_b128 v[100:103], v13 offset:6656
    s_mov_b64 exec, -1
    v_exp_f32 v22, v22
    v_cvt_pk_bf16_f32 v82, v20, v21
    v_exp_f32 v23, v23
    v_exp_f32 v24, v24
    v_cvt_pk_bf16_f32 v83, v22, v23
    v_exp_f32 v25, v25
    v_exp_f32 v26, v26
    v_mfma_f32_32x32x16_bf16 v[48:63], v[104:107], v[80:83], v[48:63]
    v_cvt_pk_bf16_f32 v84, v24, v25
    v_exp_f32 v27, v27
    v_exp_f32 v28, v28
    v_cvt_pk_bf16_f32 v85, v26, v27
    v_exp_f32 v29, v29
    v_exp_f32 v30, v30
    v_cvt_pk_bf16_f32 v86, v28, v29
    v_exp_f32 v31, v31
    s_nop 0
    v_cvt_pk_bf16_f32 v87, v30, v31
    v_exp_f32 v32, v32
    v_exp_f32 v33, v33
    v_mfma_f32_32x32x16_bf16 v[48:63], v[108:111], v[84:87], v[48:63]
    v_exp_f32 v34, v34
    v_cvt_pk_bf16_f32 v80, v32, v33
    v_exp_f32 v35, v35
    v_exp_f32 v36, v36
    v_cvt_pk_bf16_f32 v81, v34, v35
    v_exp_f32 v37, v37
    s_waitcnt lgkmcnt(2)
    v_mfma_f32_32x32x16_bf16 v[16:31], v[88:91], v[4:7], 0
    v_exp_f32 v38, v38
    v_cvt_pk_bf16_f32 v82, v36, v37
    v_exp_f32 v39, v39
    v_exp_f32 v40, v40
    v_cvt_pk_bf16_f32 v83, v38, v39
    v_exp_f32 v41, v41
    v_exp_f32 v42, v42
    v_mfma_f32_32x32x16_bf16 v[64:79], v[104:107], v[80:83], v[64:79]
    v_cvt_pk_bf16_f32 v84, v40, v41
    v_exp_f32 v43, v43
    v_exp_f32 v44, v44
    v_cvt_pk_bf16_f32 v85, v42, v43
    v_exp_f32 v45, v45
    v_exp_f32 v46, v46
    v_cvt_pk_bf16_f32 v86, v44, v45
    v_exp_f32 v47, v47
    s_waitcnt lgkmcnt(0)
    v_cvt_pk_bf16_f32 v87, v46, v47
    v_exp_f32 v16, v16
    v_exp_f32 v17, v17
    v_mfma_f32_32x32x16_bf16 v[64:79], v[108:111], v[84:87], v[64:79]
    v_exp_f32 v18, v18
    v_cvt_pk_bf16_f32 v80, v16, v17
    v_exp_f32 v19, v19
    v_exp_f32 v20, v20
    v_cvt_pk_bf16_f32 v81, v18, v19
    v_exp_f32 v21, v21
    v_mfma_f32_32x32x16_bf16 v[32:47], v[88:91], v[8:11], 0
    ds_read_b128 v[92:95], v12 offset:7168
    s_mov_b64 exec, s[56:57]
    ds_read_b128 v[104:107], v13 offset:7168
    ds_read_b128 v[108:111], v13 offset:7680
    s_mov_b64 exec, -1
    v_exp_f32 v22, v22
    v_cvt_pk_bf16_f32 v82, v20, v21
    v_exp_f32 v23, v23
    v_exp_f32 v24, v24
    v_cvt_pk_bf16_f32 v83, v22, v23
    v_exp_f32 v25, v25
    v_exp_f32 v26, v26
    v_mfma_f32_32x32x16_bf16 v[48:63], v[96:99], v[80:83], v[48:63]
    v_cvt_pk_bf16_f32 v84, v24, v25
    v_exp_f32 v27, v27
    v_exp_f32 v28, v28
    v_cvt_pk_bf16_f32 v85, v26, v27
    v_exp_f32 v29, v29
    v_exp_f32 v30, v30
    v_cvt_pk_bf16_f32 v86, v28, v29
    v_exp_f32 v31, v31
    s_nop 0
    v_cvt_pk_bf16_f32 v87, v30, v31
    s_cmp_eq_u32 s47, 0
    s_cbranch_scc1 mega_pr_37
    s_setprio 0
mega_pr_37:
    v_exp_f32 v32, v32
    v_exp_f32 v33, v33
    v_mfma_f32_32x32x16_bf16 v[48:63], v[100:103], v[84:87], v[48:63]
    v_exp_f32 v34, v34
    v_cvt_pk_bf16_f32 v80, v32, v33
    v_exp_f32 v35, v35
    v_exp_f32 v36, v36
    v_cvt_pk_bf16_f32 v81, v34, v35
    v_exp_f32 v37, v37
    s_waitcnt lgkmcnt(2)
    v_mfma_f32_32x32x16_bf16 v[16:31], v[92:95], v[4:7], 0
    v_exp_f32 v38, v38
    v_cvt_pk_bf16_f32 v82, v36, v37
    v_exp_f32 v39, v39
    v_exp_f32 v40, v40
    v_cvt_pk_bf16_f32 v83, v38, v39
    v_exp_f32 v41, v41
    v_exp_f32 v42, v42
    v_mfma_f32_32x32x16_bf16 v[64:79], v[96:99], v[80:83], v[64:79]
    v_cvt_pk_bf16_f32 v84, v40, v41
    v_exp_f32 v43, v43
    v_exp_f32 v44, v44
    v_cvt_pk_bf16_f32 v85, v42, v43
    v_exp_f32 v45, v45
    v_exp_f32 v46, v46
    v_cvt_pk_bf16_f32 v86, v44, v45
    v_exp_f32 v47, v47
    s_waitcnt lgkmcnt(0)
    v_cvt_pk_bf16_f32 v87, v46, v47
    v_exp_f32 v16, v16
    v_exp_f32 v17, v17
    v_mfma_f32_32x32x16_bf16 v[64:79], v[100:103], v[84:87], v[64:79]
    v_exp_f32 v18, v18
    v_cvt_pk_bf16_f32 v80, v16, v17
    v_exp_f32 v19, v19
    v_exp_f32 v20, v20
    v_cvt_pk_bf16_f32 v81, v18, v19
    v_exp_f32 v21, v21
    v_mfma_f32_32x32x16_bf16 v[32:47], v[92:95], v[8:11], 0
    s_cmp_lg_u32 s59, 0
    s_cbranch_scc1 mega_kvd
mega_kvw:
    ds_read_b32 v15, v14
    s_waitcnt lgkmcnt(0)
    v_readfirstlane_b32 s59, v15
    s_cmp_ge_u32 s59, 4
    s_cbranch_scc0 mega_kvw

mega_kvd:
    ds_read_b128 v[88:91], v12 offset:8192
    s_mov_b64 exec, s[56:57]
    ds_read_b128 v[96:99], v13 offset:8192
    ds_read_b128 v[100:103], v13 offset:8704
    s_mov_b64 exec, -1
    v_exp_f32 v22, v22
    v_cvt_pk_bf16_f32 v82, v20, v21
    v_exp_f32 v23, v23
    v_exp_f32 v24, v24
    v_cvt_pk_bf16_f32 v83, v22, v23
    v_exp_f32 v25, v25
    v_exp_f32 v26, v26
    v_mfma_f32_32x32x16_bf16 v[48:63], v[104:107], v[80:83], v[48:63]
    v_cvt_pk_bf16_f32 v84, v24, v25
    v_exp_f32 v27, v27
    v_exp_f32 v28, v28
    v_cvt_pk_bf16_f32 v85, v26, v27
    v_exp_f32 v29, v29
    v_exp_f32 v30, v30
    v_cvt_pk_bf16_f32 v86, v28, v29
    v_exp_f32 v31, v31
    v_add_u32 v12, 8192, v12
    v_cvt_pk_bf16_f32 v87, v30, v31
    v_add_u32 v13, 8192, v13
    v_exp_f32 v32, v32
    v_exp_f32 v33, v33
    v_mfma_f32_32x32x16_bf16 v[48:63], v[108:111], v[84:87], v[48:63]
    v_exp_f32 v34, v34
    v_cvt_pk_bf16_f32 v80, v32, v33
    v_exp_f32 v35, v35
    v_exp_f32 v36, v36
    v_cvt_pk_bf16_f32 v81, v34, v35
    v_exp_f32 v37, v37
    s_waitcnt lgkmcnt(2)
    v_mfma_f32_32x32x16_bf16 v[16:31], v[88:91], v[4:7], 0
    v_exp_f32 v38, v38
    v_cvt_pk_bf16_f32 v82, v36, v37
    v_exp_f32 v39, v39
    v_exp_f32 v40, v40
    v_cvt_pk_bf16_f32 v83, v38, v39
    v_exp_f32 v41, v41
    v_exp_f32 v42, v42
    v_mfma_f32_32x32x16_bf16 v[64:79], v[104:107], v[80:83], v[64:79]
    v_cvt_pk_bf16_f32 v84, v40, v41
    v_exp_f32 v43, v43
    v_exp_f32 v44, v44
    v_cvt_pk_bf16_f32 v85, v42, v43
    v_exp_f32 v45, v45
    v_exp_f32 v46, v46
    v_cvt_pk_bf16_f32 v86, v44, v45
    v_exp_f32 v47, v47
    s_waitcnt lgkmcnt(0)
    v_cvt_pk_bf16_f32 v87, v46, v47
    s_cmp_lg_u32 s58, 3
    s_cbranch_scc1 mega_npg
    s_mov_b64 exec, 1
    ds_add_u32 v14, v112 offset:4
    s_mov_b64 exec, -1

mega_npg:
    s_sub_u32 s58, s58, 1
    s_cmp_lg_u32 s58, 0
    s_cbranch_scc1 mega_loop

    v_mfma_f32_32x32x16_bf16 v[64:79], v[108:111], v[84:87], v[64:79]
    s_setprio 0
    s_mul_i32 s54, s40, 2304
    s_add_u32 s54, s54, 131072
    v_add_u32 v14, s54, v2
    s_xor_b32 s55, s40, 4
    s_mul_i32 s55, s55, 2304
    s_add_u32 s55, s55, 131072
    v_add_u32 v13, s55, v2
    s_add_u32 s42, s42, s47
    s_nop 7
    s_barrier
    s_cmp_eq_u32 s47, 0
    s_cbranch_scc1 mega_k1

    ds_write_b32 v14, v48 offset:0
    ds_write_b32 v14, v49 offset:256
    ds_write_b32 v14, v50 offset:512
    ds_write_b32 v14, v51 offset:768
    ds_write_b32 v14, v52 offset:1024
    ds_write_b32 v14, v53 offset:1280
    ds_write_b32 v14, v54 offset:1536
    ds_write_b32 v14, v55 offset:1792
    ds_write_b32 v14, v56 offset:2048
    v_mov_b32 v48, v64
    v_mov_b32 v49, v65
    v_mov_b32 v50, v66
    v_mov_b32 v51, v67
    v_mov_b32 v52, v68
    v_mov_b32 v53, v69
    v_mov_b32 v54, v70
    v_mov_b32 v55, v71
    v_mov_b32 v56, v72
    v_mov_b32 v4, v8
    v_mov_b32 v5, v9
    v_mov_b32 v6, v10
    v_mov_b32 v7, v11
    s_branch mega_jn
mega_k1:
    ds_write_b32 v14, v64 offset:0
    ds_write_b32 v14, v65 offset:256
    ds_write_b32 v14, v66 offset:512
    ds_write_b32 v14, v67 offset:768
    ds_write_b32 v14, v68 offset:1024
    ds_write_b32 v14, v69 offset:1280
    ds_write_b32 v14, v70 offset:1536
    ds_write_b32 v14, v71 offset:1792
    ds_write_b32 v14, v72 offset:2048
mega_jn:
    s_waitcnt lgkmcnt(0)
    s_barrier
    ds_read_b32 v16, v13 offset:0
    ds_read_b32 v17, v13 offset:256
    ds_read_b32 v18, v13 offset:512
    ds_read_b32 v19, v13 offset:768
    ds_read_b32 v20, v13 offset:1024
    ds_read_b32 v21, v13 offset:1280
    ds_read_b32 v22, v13 offset:1536
    ds_read_b32 v23, v13 offset:1792
    ds_read_b32 v24, v13 offset:2048
    s_waitcnt lgkmcnt(0)
    v_add_f32 v48, v48, v16
    v_add_f32 v49, v49, v17
    v_add_f32 v50, v50, v18
    v_add_f32 v51, v51, v19
    v_add_f32 v52, v52, v20
    v_add_f32 v53, v53, v21
    v_add_f32 v54, v54, v22
    v_add_f32 v55, v55, v23
    v_add_f32 v56, v56, v24
    v_add_f32 v14, abs(v48), abs(v49)
    v_add_f32 v14, v14, abs(v50)
    v_add_f32 v14, v14, abs(v51)
    v_add_f32 v14, v14, abs(v52)
    v_add_f32 v14, v14, abs(v53)
    v_add_f32 v14, v14, abs(v54)
    v_add_f32 v14, v14, abs(v55)
    v_cmp_le_f32 vcc, 0x21800000, v56
    s_mov_b32 s61, 0x5d800000
    v_cmp_ge_f32 s[62:63], s61, v56
    s_and_b64 vcc, vcc, s[62:63]
    s_mov_b32 s61, 0x7f800000
    v_cmp_gt_f32 s[62:63], s61, v14
    s_and_b64 vcc, vcc, s[62:63]
    s_cmp_eq_u64 vcc, -1
    s_cbranch_scc0 mega_fb

mega_fin:
    v_rcp_f32 v14, v56
    s_lshl_b32 s54, s42, 15
    s_lshl_b32 s55, s41, 10
    s_add_u32 s54, s54, s55
    s_mul_i32 s55, s3, 0x200000
    s_add_u32 s54, s54, s55
    s_add_u32 s54, s54, 0xc00000

    v_mul_f32 v48, v48, v14
    v_mul_f32 v49, v49, v14
    v_mul_f32 v50, v50, v14
    v_mul_f32 v51, v51, v14
    v_mul_f32 v52, v52, v14
    v_mul_f32 v53, v53, v14
    v_mul_f32 v54, v54, v14
    v_mul_f32 v55, v55, v14
    v_cvt_pk_bf16_f32 v80, v48, v49
    v_cvt_pk_bf16_f32 v81, v50, v51
    v_cvt_pk_bf16_f32 v82, v52, v53
    v_cvt_pk_bf16_f32 v83, v54, v55
    v_min_u32 v80, s67, v80
    v_min_u32 v81, s67, v81
    v_min_u32 v82, s67, v82
    v_min_u32 v83, s67, v83
    buffer_store_dwordx4 v[80:83], v3, s[24:27], s54 offen sc1
    s_branch mega_op
mega_help:
    s_sub_u32 s39, s40, 8
    s_lshl_b32 s51, s39, 10
    s_add_u32 s52, s48, s51
    v_mov_b32 v5, 0
    v_mov_b32 v8, 0
    v_mov_b32 v9, 0
    v_mov_b32 v10, 0
    v_mov_b32 v11, 0
    v_mov_b32 v4, 160000
    ds_write_b128 v4, v[8:11]
    ds_write_b128 v4, v[8:11] offset:16
    ds_write_b128 v4, v[8:11] offset:32
    s_lshr_b32 s41, s39, 1
    s_and_b32 s42, s39, 1
    s_lshl_b32 s38, s36, 5
    s_add_u32 s38, s38, s37
    s_lshl_b32 s43, s38, 1
    s_add_u32 s43, s43, s41
    s_mul_i32 s45, s41, 14464
    s_add_u32 s45, s45, 131072
    s_lshl_b32 s46, s43, 12
    s_lshl_b32 s44, s38, 2
    s_lshl_b32 s48, s42, 11
    v_lshrrev_b32 v6, 5, v1
    v_and_b32 v7, 31, v1
    s_movk_i32 s53, 1536
    v_mul_lo_u32 v12, v6, s53
    v_lshl_add_u32 v12, v7, 4, v12
    s_mul_i32 s49, s42, 3072
    s_add_u32 s49, s49, s45
    s_add_u32 s53, s49, 8320
    v_add_u32 v12, s53, v12
    ds_write_b128 v12, v[8:11]
    s_waitcnt lgkmcnt(0)
    s_barrier
    s_setprio 3

    v_add_u32 v41, s51, v3
    v_add_u32 v42, 0x10000, v41
    s_add_u32 s53, s52, 0x200000
    s_add_u32 s54, s52, 0x208000
    s_add_u32 s55, s52, 0x400000
    s_add_u32 s56, s52, 0x408000

    s_cmp_eq_u32 s3, 0
    s_cbranch_scc1 mega_h_nh
    v_and_b32 v14, 1, v1
    v_lshlrev_b32 v14, 15, v14
    v_lshrrev_b32 v15, 1, v1
    v_lshl_add_u32 v14, v15, 12, v14
    s_add_u32 s57, s55, 9212

    s_mov_b32 s69, 0x8000
mega_hw_38:
    s_mov_b64 exec, 0xfff
    buffer_load_dword v15, v14, s[24:27], s57 offen sc1
    s_waitcnt vmcnt(0)
    v_cmp_eq_u32 vcc, -1, v15
    s_mov_b64 exec, -1
    s_bcnt1_i32_b64 s66, vcc
    s_cmp_le_u32 s66, 3
    s_cbranch_scc1 mega_hw_38_d
    s_sub_u32 s69, s69, 1
    s_cbranch_scc1 mega_hw_38_d

    s_sleep 1
    s_branch mega_hw_38

mega_hw_38_d:
mega_h_nh:
    s_add_u32 s57, s53, 8192
    buffer_load_dwordx4 v[64:67], v3, s[24:27], s57 offen sc1
    s_add_u32 s57, s55, 8192
    buffer_load_dwordx4 v[68:71], v3, s[24:27], s57 offen sc1
    s_add_u32 s57, s54, 8192
    buffer_load_dwordx4 v[72:75], v3, s[24:27], s57 offen sc1
    s_add_u32 s57, s56, 8192
    buffer_load_dwordx4 v[76:79], v3, s[24:27], s57 offen sc1
    s_add_u32 s57, s53, 12288
    buffer_load_dwordx4 v[80:83], v3, s[24:27], s57 offen sc1
    s_add_u32 s57, s55, 12288
    buffer_load_dwordx4 v[84:87], v3, s[24:27], s57 offen sc1
    s_add_u32 s57, s54, 12288
    buffer_load_dwordx4 v[88:91], v3, s[24:27], s57 offen sc1
    s_add_u32 s57, s56, 12288
    buffer_load_dwordx4 v[92:95], v3, s[24:27], s57 offen sc1
    s_add_u32 s57, s53, 16384
    buffer_load_dwordx4 v[96:99], v3, s[24:27], s57 offen sc1
    s_add_u32 s57, s55, 16384
    buffer_load_dwordx4 v[100:103], v3, s[24:27], s57 offen sc1
    s_add_u32 s57, s54, 16384
    buffer_load_dwordx4 v[104:107], v3, s[24:27], s57 offen sc1
    s_add_u32 s57, s56, 16384
    buffer_load_dwordx4 v[108:111], v3, s[24:27], s57 offen sc1
    s_add_u32 s57, s53, 20480
    buffer_load_dwordx4 v[112:115], v3, s[24:27], s57 offen sc1
    s_add_u32 s57, s55, 20480
    buffer_load_dwordx4 v[116:119], v3, s[24:27], s57 offen sc1
    s_add_u32 s57, s54, 20480
    buffer_load_dwordx4 v[120:123], v3, s[24:27], s57 offen sc1
    s_add_u32 s57, s56, 20480
    buffer_load_dwordx4 v[124:127], v3, s[24:27], s57 offen sc1
    s_add_u32 s57, s53, 24576
    buffer_load_dwordx4 v[128:131], v3, s[24:27], s57 offen sc1
    s_add_u32 s57, s55, 24576
    buffer_load_dwordx4 v[132:135], v3, s[24:27], s57 offen sc1
    s_add_u32 s57, s54, 24576
    buffer_load_dwordx4 v[136:139], v3, s[24:27], s57 offen sc1
    s_add_u32 s57, s56, 24576
    buffer_load_dwordx4 v[140:143], v3, s[24:27], s57 offen sc1
    s_add_u32 s57, s53, 28672
    buffer_load_dwordx4 v[144:147], v3, s[24:27], s57 offen sc1
    s_add_u32 s57, s55, 28672
    buffer_load_dwordx4 v[148:151], v3, s[24:27], s57 offen sc1
    s_add_u32 s57, s54, 28672
    buffer_load_dwordx4 v[152:155], v3, s[24:27], s57 offen sc1
    s_add_u32 s57, s56, 28672
    buffer_load_dwordx4 v[156:159], v3, s[24:27], s57 offen sc1
    s_cmp_lg_u32 s3, 0
    s_cbranch_scc1 mega_hkv

    s_load_dword s47, s[12:13], s44
    s_add_u32 s20, s16, s46
    s_addc_u32 s21, s17, 0
    s_movk_i32 s22, 0x1000
    s_mov_b32 s23, 0x00020000
    v_add_u32 v13, s48, v3

    buffer_load_dwordx4 v[48:51], v13, s[20:23], 0 offen offset:0
    buffer_load_dwordx4 v[52:55], v13, s[20:23], 0 offen offset:4
    buffer_load_dwordx4 v[56:59], v13, s[20:23], 0 offen offset:1024
    buffer_load_dwordx4 v[60:63], v13, s[20:23], 0 offen offset:1028
    buffer_load_dword v40, v5, s[20:23], 0 offen

mega_hkv:
    s_mov_b32 s69, 0x8000
    s_mov_b32 s66, 0xff
    s_cmp_lg_u32 s3, 0
    s_cbranch_scc1 mega_hw_40
    s_waitcnt vmcnt(21)
    s_branch mega_hw_40_d

mega_hw_40:
    s_waitcnt vmcnt(16)
mega_hw_40_d:
    v_max3_u32 v15, v64, v65, v66
    v_max3_u32 v15, v15, v67, v68
    v_max3_u32 v15, v15, v69, v70
    v_max3_u32 v15, v15, v71, v72
    v_max3_u32 v15, v15, v73, v74
    v_max3_u32 v15, v15, v75, v76
    v_max3_u32 v15, v15, v77, v78
    v_max3_u32 v15, v15, v79, v80
    v_max3_u32 v15, v15, v81, v82
    v_max3_u32 v15, v15, v83, v84
    v_max3_u32 v15, v15, v85, v86
    v_max3_u32 v15, v15, v87, v88
    v_max3_u32 v15, v15, v89, v90
    v_max3_u32 v15, v15, v91, v92
    v_max3_u32 v15, v15, v93, v94
    v_max_u32 v15, v15, v95
    v_cmp_eq_u32 vcc, -1, v15
    s_cmp_eq_u64 vcc, 0
    s_cbranch_scc0 mega_cu_39_c

    ds_write_b128 v41, v[64:67] offset:8192
    ds_write_b128 v42, v[68:71] offset:8192
    ds_write_b128 v41, v[72:75] offset:40960
    ds_write_b128 v42, v[76:79] offset:40960
    ds_write_b128 v41, v[80:83] offset:12288
    ds_write_b128 v42, v[84:87] offset:12288
    ds_write_b128 v41, v[88:91] offset:45056
    ds_write_b128 v42, v[92:95] offset:45056
    s_branch mega_cu_39_d
mega_cu_39:
    s_bitcmp1_b32 s66, 0
    s_cbranch_scc0 mega_cu_39_l0
    s_add_u32 s57, s53, 8192
    buffer_load_dwordx4 v[64:67], v3, s[24:27], s57 offen sc1
mega_cu_39_l0:
    s_bitcmp1_b32 s66, 1
    s_cbranch_scc0 mega_cu_39_l1
    s_add_u32 s57, s55, 8192
    buffer_load_dwordx4 v[68:71], v3, s[24:27], s57 offen sc1
mega_cu_39_l1:
    s_bitcmp1_b32 s66, 2
    s_cbranch_scc0 mega_cu_39_l2
    s_add_u32 s57, s54, 8192
    buffer_load_dwordx4 v[72:75], v3, s[24:27], s57 offen sc1
mega_cu_39_l2:
    s_bitcmp1_b32 s66, 3
    s_cbranch_scc0 mega_cu_39_l3
    s_add_u32 s57, s56, 8192
    buffer_load_dwordx4 v[76:79], v3, s[24:27], s57 offen sc1
mega_cu_39_l3:
    s_bitcmp1_b32 s66, 4
    s_cbranch_scc0 mega_cu_39_l4
    s_add_u32 s57, s53, 12288
    buffer_load_dwordx4 v[80:83], v3, s[24:27], s57 offen sc1
mega_cu_39_l4:
    s_bitcmp1_b32 s66, 5
    s_cbranch_scc0 mega_cu_39_l5
    s_add_u32 s57, s55, 12288
    buffer_load_dwordx4 v[84:87], v3, s[24:27], s57 offen sc1
mega_cu_39_l5:
    s_bitcmp1_b32 s66, 6
    s_cbranch_scc0 mega_cu_39_l6
    s_add_u32 s57, s54, 12288
    buffer_load_dwordx4 v[88:91], v3, s[24:27], s57 offen sc1
mega_cu_39_l6:
    s_bitcmp1_b32 s66, 7
    s_cbranch_scc0 mega_cu_39_l7
    s_add_u32 s57, s56, 12288
    buffer_load_dwordx4 v[92:95], v3, s[24:27], s57 offen sc1
mega_cu_39_l7:
    s_waitcnt vmcnt(0)
mega_cu_39_c:
    s_bitcmp1_b32 s66, 0
    s_cbranch_scc0 mega_cu_39_k0
    v_max3_u32 v15, v64, v65, v66
    v_max_u32 v15, v15, v67
    v_cmp_eq_u32 vcc, -1, v15
    s_cmp_eq_u64 vcc, 0
    s_cbranch_scc0 mega_cu_39_k0
    s_bitset0_b32 s66, 0

    ds_write_b128 v41, v[64:67] offset:8192
mega_cu_39_k0:
    s_bitcmp1_b32 s66, 1
    s_cbranch_scc0 mega_cu_39_k1
    v_max3_u32 v15, v68, v69, v70
    v_max_u32 v15, v15, v71
    v_cmp_eq_u32 vcc, -1, v15
    s_cmp_eq_u64 vcc, 0
    s_cbranch_scc0 mega_cu_39_k1
    s_bitset0_b32 s66, 1

    ds_write_b128 v42, v[68:71] offset:8192
mega_cu_39_k1:
    s_bitcmp1_b32 s66, 2
    s_cbranch_scc0 mega_cu_39_k2
    v_max3_u32 v15, v72, v73, v74
    v_max_u32 v15, v15, v75
    v_cmp_eq_u32 vcc, -1, v15
    s_cmp_eq_u64 vcc, 0
    s_cbranch_scc0 mega_cu_39_k2
    s_bitset0_b32 s66, 2

    ds_write_b128 v41, v[72:75] offset:40960
mega_cu_39_k2:
    s_bitcmp1_b32 s66, 3
    s_cbranch_scc0 mega_cu_39_k3
    v_max3_u32 v15, v76, v77, v78
    v_max_u32 v15, v15, v79
    v_cmp_eq_u32 vcc, -1, v15
    s_cmp_eq_u64 vcc, 0
    s_cbranch_scc0 mega_cu_39_k3
    s_bitset0_b32 s66, 3

    ds_write_b128 v42, v[76:79] offset:40960
mega_cu_39_k3:
    s_bitcmp1_b32 s66, 4
    s_cbranch_scc0 mega_cu_39_k4
    v_max3_u32 v15, v80, v81, v82
    v_max_u32 v15, v15, v83
    v_cmp_eq_u32 vcc, -1, v15
    s_cmp_eq_u64 vcc, 0
    s_cbranch_scc0 mega_cu_39_k4
    s_bitset0_b32 s66, 4

    ds_write_b128 v41, v[80:83] offset:12288
mega_cu_39_k4:
    s_bitcmp1_b32 s66, 5
    s_cbranch_scc0 mega_cu_39_k5
    v_max3_u32 v15, v84, v85, v86
    v_max_u32 v15, v15, v87
    v_cmp_eq_u32 vcc, -1, v15
    s_cmp_eq_u64 vcc, 0
    s_cbranch_scc0 mega_cu_39_k5
    s_bitset0_b32 s66, 5

    ds_write_b128 v42, v[84:87] offset:12288
mega_cu_39_k5:
    s_bitcmp1_b32 s66, 6
    s_cbranch_scc0 mega_cu_39_k6
    v_max3_u32 v15, v88, v89, v90
    v_max_u32 v15, v15, v91
    v_cmp_eq_u32 vcc, -1, v15
    s_cmp_eq_u64 vcc, 0
    s_cbranch_scc0 mega_cu_39_k6
    s_bitset0_b32 s66, 6

    ds_write_b128 v41, v[88:91] offset:45056
mega_cu_39_k6:
    s_bitcmp1_b32 s66, 7
    s_cbranch_scc0 mega_cu_39_k7
    v_max3_u32 v15, v92, v93, v94
    v_max_u32 v15, v15, v95
    v_cmp_eq_u32 vcc, -1, v15
    s_cmp_eq_u64 vcc, 0
    s_cbranch_scc0 mega_cu_39_k7
    s_bitset0_b32 s66, 7

    ds_write_b128 v42, v[92:95] offset:45056
mega_cu_39_k7:
    s_cmp_eq_u32 s66, 0
    s_cbranch_scc1 mega_cu_39_d
    s_sub_u32 s69, s69, 1
    s_cbranch_scc1 mega_cu_39_d

    s_sleep 1
    s_branch mega_cu_39

mega_cu_39_d:
    s_mov_b32 s69, 0x8000
    s_mov_b32 s66, 0xff
    s_cmp_lg_u32 s3, 0
    s_cbranch_scc1 mega_hw_42
    s_waitcnt vmcnt(13)
    s_branch mega_hw_42_d

mega_hw_42:
    s_waitcnt vmcnt(8)
mega_hw_42_d:
    v_max3_u32 v15, v96, v97, v98
    v_max3_u32 v15, v15, v99, v100
    v_max3_u32 v15, v15, v101, v102
    v_max3_u32 v15, v15, v103, v104
    v_max3_u32 v15, v15, v105, v106
    v_max3_u32 v15, v15, v107, v108
    v_max3_u32 v15, v15, v109, v110
    v_max3_u32 v15, v15, v111, v112
    v_max3_u32 v15, v15, v113, v114
    v_max3_u32 v15, v15, v115, v116
    v_max3_u32 v15, v15, v117, v118
    v_max3_u32 v15, v15, v119, v120
    v_max3_u32 v15, v15, v121, v122
    v_max3_u32 v15, v15, v123, v124
    v_max3_u32 v15, v15, v125, v126
    v_max_u32 v15, v15, v127
    v_cmp_eq_u32 vcc, -1, v15
    s_cmp_eq_u64 vcc, 0
    s_cbranch_scc0 mega_cu_41_c

    ds_write_b128 v41, v[96:99] offset:16384
    ds_write_b128 v42, v[100:103] offset:16384
    ds_write_b128 v41, v[104:107] offset:49152
    ds_write_b128 v42, v[108:111] offset:49152
    ds_write_b128 v41, v[112:115] offset:20480
    ds_write_b128 v42, v[116:119] offset:20480
    ds_write_b128 v41, v[120:123] offset:53248
    ds_write_b128 v42, v[124:127] offset:53248
    s_branch mega_cu_41_d
mega_cu_41:
    s_bitcmp1_b32 s66, 0
    s_cbranch_scc0 mega_cu_41_l0
    s_add_u32 s57, s53, 16384
    buffer_load_dwordx4 v[96:99], v3, s[24:27], s57 offen sc1
mega_cu_41_l0:
    s_bitcmp1_b32 s66, 1
    s_cbranch_scc0 mega_cu_41_l1
    s_add_u32 s57, s55, 16384
    buffer_load_dwordx4 v[100:103], v3, s[24:27], s57 offen sc1
mega_cu_41_l1:
    s_bitcmp1_b32 s66, 2
    s_cbranch_scc0 mega_cu_41_l2
    s_add_u32 s57, s54, 16384
    buffer_load_dwordx4 v[104:107], v3, s[24:27], s57 offen sc1
mega_cu_41_l2:
    s_bitcmp1_b32 s66, 3
    s_cbranch_scc0 mega_cu_41_l3
    s_add_u32 s57, s56, 16384
    buffer_load_dwordx4 v[108:111], v3, s[24:27], s57 offen sc1
mega_cu_41_l3:
    s_bitcmp1_b32 s66, 4
    s_cbranch_scc0 mega_cu_41_l4
    s_add_u32 s57, s53, 20480
    buffer_load_dwordx4 v[112:115], v3, s[24:27], s57 offen sc1
mega_cu_41_l4:
    s_bitcmp1_b32 s66, 5
    s_cbranch_scc0 mega_cu_41_l5
    s_add_u32 s57, s55, 20480
    buffer_load_dwordx4 v[116:119], v3, s[24:27], s57 offen sc1
mega_cu_41_l5:
    s_bitcmp1_b32 s66, 6
    s_cbranch_scc0 mega_cu_41_l6
    s_add_u32 s57, s54, 20480
    buffer_load_dwordx4 v[120:123], v3, s[24:27], s57 offen sc1
mega_cu_41_l6:
    s_bitcmp1_b32 s66, 7
    s_cbranch_scc0 mega_cu_41_l7
    s_add_u32 s57, s56, 20480
    buffer_load_dwordx4 v[124:127], v3, s[24:27], s57 offen sc1
mega_cu_41_l7:
    s_waitcnt vmcnt(0)
mega_cu_41_c:
    s_bitcmp1_b32 s66, 0
    s_cbranch_scc0 mega_cu_41_k0
    v_max3_u32 v15, v96, v97, v98
    v_max_u32 v15, v15, v99
    v_cmp_eq_u32 vcc, -1, v15
    s_cmp_eq_u64 vcc, 0
    s_cbranch_scc0 mega_cu_41_k0
    s_bitset0_b32 s66, 0

    ds_write_b128 v41, v[96:99] offset:16384
mega_cu_41_k0:
    s_bitcmp1_b32 s66, 1
    s_cbranch_scc0 mega_cu_41_k1
    v_max3_u32 v15, v100, v101, v102
    v_max_u32 v15, v15, v103
    v_cmp_eq_u32 vcc, -1, v15
    s_cmp_eq_u64 vcc, 0
    s_cbranch_scc0 mega_cu_41_k1
    s_bitset0_b32 s66, 1

    ds_write_b128 v42, v[100:103] offset:16384
mega_cu_41_k1:
    s_bitcmp1_b32 s66, 2
    s_cbranch_scc0 mega_cu_41_k2
    v_max3_u32 v15, v104, v105, v106
    v_max_u32 v15, v15, v107
    v_cmp_eq_u32 vcc, -1, v15
    s_cmp_eq_u64 vcc, 0
    s_cbranch_scc0 mega_cu_41_k2
    s_bitset0_b32 s66, 2

    ds_write_b128 v41, v[104:107] offset:49152
mega_cu_41_k2:
    s_bitcmp1_b32 s66, 3
    s_cbranch_scc0 mega_cu_41_k3
    v_max3_u32 v15, v108, v109, v110
    v_max_u32 v15, v15, v111
    v_cmp_eq_u32 vcc, -1, v15
    s_cmp_eq_u64 vcc, 0
    s_cbranch_scc0 mega_cu_41_k3
    s_bitset0_b32 s66, 3

    ds_write_b128 v42, v[108:111] offset:49152
mega_cu_41_k3:
    s_bitcmp1_b32 s66, 4
    s_cbranch_scc0 mega_cu_41_k4
    v_max3_u32 v15, v112, v113, v114
    v_max_u32 v15, v15, v115
    v_cmp_eq_u32 vcc, -1, v15
    s_cmp_eq_u64 vcc, 0
    s_cbranch_scc0 mega_cu_41_k4
    s_bitset0_b32 s66, 4

    ds_write_b128 v41, v[112:115] offset:20480
mega_cu_41_k4:
    s_bitcmp1_b32 s66, 5
    s_cbranch_scc0 mega_cu_41_k5
    v_max3_u32 v15, v116, v117, v118
    v_max_u32 v15, v15, v119
    v_cmp_eq_u32 vcc, -1, v15
    s_cmp_eq_u64 vcc, 0
    s_cbranch_scc0 mega_cu_41_k5
    s_bitset0_b32 s66, 5

    ds_write_b128 v42, v[116:119] offset:20480
mega_cu_41_k5:
    s_bitcmp1_b32 s66, 6
    s_cbranch_scc0 mega_cu_41_k6
    v_max3_u32 v15, v120, v121, v122
    v_max_u32 v15, v15, v123
    v_cmp_eq_u32 vcc, -1, v15
    s_cmp_eq_u64 vcc, 0
    s_cbranch_scc0 mega_cu_41_k6
    s_bitset0_b32 s66, 6

    ds_write_b128 v41, v[120:123] offset:53248
mega_cu_41_k6:
    s_bitcmp1_b32 s66, 7
    s_cbranch_scc0 mega_cu_41_k7
    v_max3_u32 v15, v124, v125, v126
    v_max_u32 v15, v15, v127
    v_cmp_eq_u32 vcc, -1, v15
    s_cmp_eq_u64 vcc, 0
    s_cbranch_scc0 mega_cu_41_k7
    s_bitset0_b32 s66, 7

    ds_write_b128 v42, v[124:127] offset:53248
mega_cu_41_k7:
    s_cmp_eq_u32 s66, 0
    s_cbranch_scc1 mega_cu_41_d
    s_sub_u32 s69, s69, 1
    s_cbranch_scc1 mega_cu_41_d

    s_sleep 1
    s_branch mega_cu_41

mega_cu_41_d:
    s_mov_b32 s69, 0x8000
    s_mov_b32 s66, 0xff
    s_cmp_lg_u32 s3, 0
    s_cbranch_scc1 mega_hw_44
    s_waitcnt vmcnt(5)
    s_branch mega_hw_44_d

mega_hw_44:
    s_waitcnt vmcnt(0)
mega_hw_44_d:
    v_max3_u32 v15, v128, v129, v130
    v_max3_u32 v15, v15, v131, v132
    v_max3_u32 v15, v15, v133, v134
    v_max3_u32 v15, v15, v135, v136
    v_max3_u32 v15, v15, v137, v138
    v_max3_u32 v15, v15, v139, v140
    v_max3_u32 v15, v15, v141, v142
    v_max3_u32 v15, v15, v143, v144
    v_max3_u32 v15, v15, v145, v146
    v_max3_u32 v15, v15, v147, v148
    v_max3_u32 v15, v15, v149, v150
    v_max3_u32 v15, v15, v151, v152
    v_max3_u32 v15, v15, v153, v154
    v_max3_u32 v15, v15, v155, v156
    v_max3_u32 v15, v15, v157, v158
    v_max_u32 v15, v15, v159
    v_cmp_eq_u32 vcc, -1, v15
    s_cmp_eq_u64 vcc, 0
    s_cbranch_scc0 mega_cu_43_c

    ds_write_b128 v41, v[128:131] offset:24576
    ds_write_b128 v42, v[132:135] offset:24576
    ds_write_b128 v41, v[136:139] offset:57344
    ds_write_b128 v42, v[140:143] offset:57344
    ds_write_b128 v41, v[144:147] offset:28672
    ds_write_b128 v42, v[148:151] offset:28672
    ds_write_b128 v41, v[152:155] offset:61440
    ds_write_b128 v42, v[156:159] offset:61440
    s_branch mega_cu_43_d
mega_cu_43:
    s_bitcmp1_b32 s66, 0
    s_cbranch_scc0 mega_cu_43_l0
    s_add_u32 s57, s53, 24576
    buffer_load_dwordx4 v[128:131], v3, s[24:27], s57 offen sc1
mega_cu_43_l0:
    s_bitcmp1_b32 s66, 1
    s_cbranch_scc0 mega_cu_43_l1
    s_add_u32 s57, s55, 24576
    buffer_load_dwordx4 v[132:135], v3, s[24:27], s57 offen sc1
mega_cu_43_l1:
    s_bitcmp1_b32 s66, 2
    s_cbranch_scc0 mega_cu_43_l2
    s_add_u32 s57, s54, 24576
    buffer_load_dwordx4 v[136:139], v3, s[24:27], s57 offen sc1
mega_cu_43_l2:
    s_bitcmp1_b32 s66, 3
    s_cbranch_scc0 mega_cu_43_l3
    s_add_u32 s57, s56, 24576
    buffer_load_dwordx4 v[140:143], v3, s[24:27], s57 offen sc1
mega_cu_43_l3:
    s_bitcmp1_b32 s66, 4
    s_cbranch_scc0 mega_cu_43_l4
    s_add_u32 s57, s53, 28672
    buffer_load_dwordx4 v[144:147], v3, s[24:27], s57 offen sc1
mega_cu_43_l4:
    s_bitcmp1_b32 s66, 5
    s_cbranch_scc0 mega_cu_43_l5
    s_add_u32 s57, s55, 28672
    buffer_load_dwordx4 v[148:151], v3, s[24:27], s57 offen sc1
mega_cu_43_l5:
    s_bitcmp1_b32 s66, 6
    s_cbranch_scc0 mega_cu_43_l6
    s_add_u32 s57, s54, 28672
    buffer_load_dwordx4 v[152:155], v3, s[24:27], s57 offen sc1
mega_cu_43_l6:
    s_bitcmp1_b32 s66, 7
    s_cbranch_scc0 mega_cu_43_l7
    s_add_u32 s57, s56, 28672
    buffer_load_dwordx4 v[156:159], v3, s[24:27], s57 offen sc1
mega_cu_43_l7:
    s_waitcnt vmcnt(0)
mega_cu_43_c:
    s_bitcmp1_b32 s66, 0
    s_cbranch_scc0 mega_cu_43_k0
    v_max3_u32 v15, v128, v129, v130
    v_max_u32 v15, v15, v131
    v_cmp_eq_u32 vcc, -1, v15
    s_cmp_eq_u64 vcc, 0
    s_cbranch_scc0 mega_cu_43_k0
    s_bitset0_b32 s66, 0

    ds_write_b128 v41, v[128:131] offset:24576
mega_cu_43_k0:
    s_bitcmp1_b32 s66, 1
    s_cbranch_scc0 mega_cu_43_k1
    v_max3_u32 v15, v132, v133, v134
    v_max_u32 v15, v15, v135
    v_cmp_eq_u32 vcc, -1, v15
    s_cmp_eq_u64 vcc, 0
    s_cbranch_scc0 mega_cu_43_k1
    s_bitset0_b32 s66, 1

    ds_write_b128 v42, v[132:135] offset:24576
mega_cu_43_k1:
    s_bitcmp1_b32 s66, 2
    s_cbranch_scc0 mega_cu_43_k2
    v_max3_u32 v15, v136, v137, v138
    v_max_u32 v15, v15, v139
    v_cmp_eq_u32 vcc, -1, v15
    s_cmp_eq_u64 vcc, 0
    s_cbranch_scc0 mega_cu_43_k2
    s_bitset0_b32 s66, 2

    ds_write_b128 v41, v[136:139] offset:57344
mega_cu_43_k2:
    s_bitcmp1_b32 s66, 3
    s_cbranch_scc0 mega_cu_43_k3
    v_max3_u32 v15, v140, v141, v142
    v_max_u32 v15, v15, v143
    v_cmp_eq_u32 vcc, -1, v15
    s_cmp_eq_u64 vcc, 0
    s_cbranch_scc0 mega_cu_43_k3
    s_bitset0_b32 s66, 3

    ds_write_b128 v42, v[140:143] offset:57344
mega_cu_43_k3:
    s_bitcmp1_b32 s66, 4
    s_cbranch_scc0 mega_cu_43_k4
    v_max3_u32 v15, v144, v145, v146
    v_max_u32 v15, v15, v147
    v_cmp_eq_u32 vcc, -1, v15
    s_cmp_eq_u64 vcc, 0
    s_cbranch_scc0 mega_cu_43_k4
    s_bitset0_b32 s66, 4

    ds_write_b128 v41, v[144:147] offset:28672
mega_cu_43_k4:
    s_bitcmp1_b32 s66, 5
    s_cbranch_scc0 mega_cu_43_k5
    v_max3_u32 v15, v148, v149, v150
    v_max_u32 v15, v15, v151
    v_cmp_eq_u32 vcc, -1, v15
    s_cmp_eq_u64 vcc, 0
    s_cbranch_scc0 mega_cu_43_k5
    s_bitset0_b32 s66, 5

    ds_write_b128 v42, v[148:151] offset:28672
mega_cu_43_k5:
    s_bitcmp1_b32 s66, 6
    s_cbranch_scc0 mega_cu_43_k6
    v_max3_u32 v15, v152, v153, v154
    v_max_u32 v15, v15, v155
    v_cmp_eq_u32 vcc, -1, v15
    s_cmp_eq_u64 vcc, 0
    s_cbranch_scc0 mega_cu_43_k6
    s_bitset0_b32 s66, 6

    ds_write_b128 v41, v[152:155] offset:61440
mega_cu_43_k6:
    s_bitcmp1_b32 s66, 7
    s_cbranch_scc0 mega_cu_43_k7
    v_max3_u32 v15, v156, v157, v158
    v_max_u32 v15, v15, v159
    v_cmp_eq_u32 vcc, -1, v15
    s_cmp_eq_u64 vcc, 0
    s_cbranch_scc0 mega_cu_43_k7
    s_bitset0_b32 s66, 7

    ds_write_b128 v42, v[156:159] offset:61440
mega_cu_43_k7:
    s_cmp_eq_u32 s66, 0
    s_cbranch_scc1 mega_cu_43_d
    s_sub_u32 s69, s69, 1
    s_cbranch_scc1 mega_cu_43_d

    s_sleep 1
    s_branch mega_cu_43

mega_cu_43_d:
    v_mov_b32 v15, 1
    s_waitcnt lgkmcnt(0)
    s_mov_b64 exec, 1
    ds_add_u32 v4, v15 offset:4
    s_mov_b64 exec, -1
    s_cmp_lg_u32 s3, 0
    s_cbranch_scc1 mega_hend

    s_lshl_b32 s50, s36, 9
    s_add_u32 s50, s50, 0x1560000

    s_add_u32 s50, s46, s48
    s_add_u32 m0, s49, 8832
    s_add_u32 s57, s50, 0x1800000
    buffer_load_dwordx4 v3, s[24:27], s57 offen sc1 lds
    s_add_u32 m0, s49, 10368
    s_add_u32 s57, s50, 0x1800400
    buffer_load_dwordx4 v3, s[24:27], s57 offen sc1 lds

    s_mov_b32 s20, s34
    s_mov_b32 s21, s35
    s_mov_b32 s22, 0x180000
    v_lshrrev_b32 v12, 2, v1
    s_movk_i32 s52, 3072
    v_mul_lo_u32 v12, v12, s52
    v_and_b32 v13, 3, v1
    v_lshl_add_u32 v12, v13, 4, v12
    s_lshr_b32 s52, s2, 4
    s_and_b32 s53, s2, 15
    s_min_u32 s56, s39, 2
    s_lshl_b32 s57, s56, 10
    s_lshl_b32 s58, s53, 6
    s_add_u32 s57, s57, s58
    s_mul_i32 s58, s52, 98304
    s_add_u32 s57, s57, s58
    buffer_load_dwordx4 v[152:155], v12, s[20:23], s57 offen
    s_add_u32 s57, s57, 49152
    buffer_load_dwordx4 v[156:159], v12, s[20:23], s57 offen
    s_mul_i32 s55, s53, 98304
    s_lshr_b32 s58, s52, 1
    s_mul_i32 s58, s58, 12288
    s_add_u32 s55, s55, s58
    s_and_b32 s58, s52, 1
    s_lshl_b32 s58, s58, 11
    s_add_u32 s55, s55, s58
    s_lshl_b32 s56, s56, 12
    s_add_u32 s55, s55, s56
    s_add_u32 s33, s55, 0x1600000

    v_mov_b32 v160, -1
    v_mov_b32 v161, -1
    v_mov_b32 v162, -1
    v_mov_b32 v163, -1
    s_lshl_b32 s58, s36, 2
    s_and_b32 s59, s37, 3
    s_add_u32 s58, s58, s59
    s_lshr_b32 s59, s37, 2
    s_lshl_b32 s50, s59, 18
    s_lshl_b32 s64, s39, 16
    s_add_u32 s50, s50, s64
    s_lshl_b32 s64, s58, 10
    s_add_u32 s50, s50, s64

    s_add_u32 s64, s50, 0xc00000
    buffer_store_dwordx4 v[160:163], v3, s[24:27], s64 offen sc1
    s_add_u32 s64, s50, 0xc08000
    buffer_store_dwordx4 v[160:163], v3, s[24:27], s64 offen sc1
    s_add_u32 s64, s50, 0xe00000
    buffer_store_dwordx4 v[160:163], v3, s[24:27], s64 offen sc1
    s_add_u32 s64, s50, 0xe08000
    buffer_store_dwordx4 v[160:163], v3, s[24:27], s64 offen sc1
    s_lshl_b32 s50, s58, 1
    s_add_u32 s50, s50, s42
    s_lshl_b32 s64, s50, 15
    s_lshl_b32 s66, s59, 12
    s_add_u32 s64, s64, s66
    s_lshl_b32 s66, s41, 11
    s_add_u32 s64, s64, s66
    s_add_u32 s64, s64, 0x1000000
    buffer_store_dwordx4 v[160:163], v3, s[24:27], s64 offen sc1
    buffer_store_dwordx4 v[160:163], v3, s[24:27], s64 offen offset:1024 sc1
    s_add_u32 s64, s64, 0x1000000
    buffer_store_dwordx4 v[160:163], v3, s[24:27], s64 offen sc1
    buffer_store_dwordx4 v[160:163], v3, s[24:27], s64 offen offset:1024 sc1
    s_lshl_b32 s64, s50, 12
    s_lshl_b32 s66, s59, 9
    s_add_u32 s64, s64, s66
    s_lshl_b32 s66, s41, 8
    s_add_u32 s64, s64, s66
    s_add_u32 s64, s64, 0x1510000
    buffer_store_dword v160, v2, s[24:27], s64 offen sc1
    s_add_u32 s64, s64, 0x1000000
    buffer_store_dword v160, v2, s[24:27], s64 offen sc1
    s_sub_u32 s64, s64, 0x2510000
    s_lshl_b32 s64, s64, 1
    s_add_u32 s64, s64, 0x1400000
    s_mov_b64 exec, 0xffffffff
    buffer_store_dwordx4 v[160:163], v3, s[24:27], s64 offen
    s_add_u32 s64, s64, 0x80000
    buffer_store_dwordx4 v[160:163], v3, s[24:27], s64 offen
    s_mov_b64 exec, -1
    s_lshl_b32 s50, s36, 1
    s_and_b32 s64, s37, 1
    s_add_u32 s50, s50, s64
    s_lshl_b32 s50, s50, 2
    s_add_u32 s50, s50, s39
    s_lshl_b32 s50, s50, 10
    s_lshr_b32 s64, s37, 1
    s_lshl_b32 s64, s64, 17
    s_add_u32 s50, s50, s64

    s_add_u32 s64, s50, 0x600000
    buffer_store_dwordx4 v[160:163], v3, s[24:27], s64 offen sc1
    s_add_u32 s64, s50, 0x610000
    buffer_store_dwordx4 v[160:163], v3, s[24:27], s64 offen sc1
    s_add_u32 s64, s50, 0x800000
    buffer_store_dwordx4 v[160:163], v3, s[24:27], s64 offen sc1
    s_add_u32 s64, s50, 0x810000
    buffer_store_dwordx4 v[160:163], v3, s[24:27], s64 offen sc1
    s_add_u32 s64, s50, 0xa00000
    buffer_store_dwordx4 v[160:163], v3, s[24:27], s64 offen sc1
    s_add_u32 s64, s50, 0xa10000
    buffer_store_dwordx4 v[160:163], v3, s[24:27], s64 offen sc1
    s_add_u32 s52, s45, s48
    v_add_u32 v13, s52, v3
    s_waitcnt vmcnt(18)

    v_alignbyte_b32 v44, v52, v48, 2
    v_alignbyte_b32 v45, v53, v49, 2
    v_alignbyte_b32 v46, v54, v50, 2
    v_alignbyte_b32 v47, v55, v51, 2
    ds_write_b128 v13, v[44:47] offset:64
    ds_write_b128 v13, v[52:55] offset:4224
    v_alignbyte_b32 v44, v60, v56, 2
    v_alignbyte_b32 v45, v61, v57, 2
    v_alignbyte_b32 v46, v62, v58, 2
    v_alignbyte_b32 v47, v63, v59, 2
    ds_write_b128 v13, v[44:47] offset:1088
    ds_write_b128 v13, v[60:63] offset:5248
    s_cmp_lg_u32 s42, 0
    s_cbranch_scc1 mega_hs
    v_lshlrev_b32 v44, 16, v40
    v_cmp_eq_u32 vcc, 3, v1
    s_nop 1
    v_cndmask_b32 v11, v11, v44, vcc
    v_cmp_eq_u32 vcc, 7, v1
    s_nop 1
    v_cndmask_b32 v11, v11, v40, vcc
    v_lshrrev_b32 v12, 2, v1
    s_movk_i32 s52, 4160
    v_mul_lo_u32 v12, v12, s52
    v_and_b32 v14, 3, v1
    v_lshl_add_u32 v12, v14, 4, v12
    v_add_u32 v12, s45, v12
    s_mov_b64 exec, 0xff
    ds_write_b128 v12, v[8:11]
    s_mov_b64 exec, -1

mega_hs:
    v_mov_b32 v5, 1
    s_waitcnt lgkmcnt(0)
    s_mov_b64 exec, 1
    ds_add_u32 v4, v5
    s_mov_b64 exec, -1
    v_and_b32 v12, 1, v1
    s_movk_i32 s52, 4158
    v_mul_lo_u32 v12, v12, s52
    v_and_b32 v14, 19, v1
    v_lshl_add_u32 v12, v14, 1, v12
    v_bfe_u32 v14, v1, 2, 1
    v_lshl_add_u32 v12, v14, 4, v12
    v_bfe_u32 v14, v1, 3, 1
    v_lshl_add_u32 v12, v14, 3, v12
    v_lshlrev_b32 v14, 4, v6
    v_sub_u32 v12, v12, v14
    s_add_u32 s53, s45, 16
    v_add_u32 v12, s53, v12
    s_movk_i32 s52, 1536
    v_mul_lo_u32 v13, v6, s52
    v_lshl_add_u32 v13, v7, 4, v13
    s_lshl_b32 s59, s42, 9
    s_add_u32 s53, s45, s59
    s_add_u32 s53, s53, 8320
    v_add_u32 v8, s53, v13
    v_subrev_u32 v13, 64, v8
    s_lshl_b32 s55, s42, 2
    s_add_u32 s55, s55, 8

    v_mov_b32 v64, 0
    v_mov_b32 v65, 0
    v_mov_b32 v66, 0
    v_mov_b32 v67, 0
    v_mov_b32 v68, 0
    v_mov_b32 v69, 0
    v_mov_b32 v70, 0
    v_mov_b32 v71, 0
    v_mov_b32 v72, 0
    v_mov_b32 v73, 0
    v_mov_b32 v74, 0
    v_mov_b32 v75, 0
    v_mov_b32 v76, 0
    v_mov_b32 v77, 0
    v_mov_b32 v78, 0
    v_mov_b32 v79, 0
mega_cw:
    ds_read_b32 v5, v4
    s_waitcnt lgkmcnt(0)
    v_readfirstlane_b32 s52, v5
    s_cmp_ge_u32 s52, 4
    s_cbranch_scc1 mega_cwd
    s_sleep 2
    s_branch mega_cw

mega_cwd:
    buffer_store_dwordx4 v[152:155], v3, s[24:27], s33 offen sc1
    buffer_store_dwordx4 v[156:159], v3, s[24:27], s33 offen offset:1024 sc1

    s_lshl_b32 s53, s2, 4
    s_lshl_b32 s54, s39, 2
    s_add_u32 s53, s53, s54
    s_add_u32 s53, s53, 0x1561000

    v_mov_b32 v15, s65
    v_mov_b32 v14, 0
    s_waitcnt vmcnt(0)
    s_mov_b64 exec, 1
    buffer_store_dword v15, v14, s[24:27], s53 offen sc1
    s_mov_b64 exec, -1

    s_lshl_b32 s53, s37, 14
    s_lshl_b32 s54, s39, 12
    s_add_u32 s53, s53, s54
    s_mov_b32 s20, s6
    s_mov_b32 s21, s7
    s_mov_b32 s22, 0x80000
    v_lshlrev_b32 v80, 6, v1
    buffer_load_dword v81, v80, s[20:23], s53 offen

    v_mov_b32 v116, 0
    v_mov_b32 v117, 0
    v_mov_b32 v118, 0
    v_mov_b32 v119, 0
    v_mov_b32 v120, 0
    v_mov_b32 v121, 0
    v_mov_b32 v122, 0
    v_mov_b32 v123, 0
    v_mov_b32 v124, 0
    v_mov_b32 v125, 0
    v_mov_b32 v126, 0
    v_mov_b32 v127, 0
    v_mov_b32 v128, 0
    v_mov_b32 v129, 0
    v_mov_b32 v130, 0
    v_mov_b32 v131, 0
    ds_read2_b32 v[16:17], v12 offset0:8 offset1:9
    ds_read2_b32 v[18:19], v12 offset0:10 offset1:11
    ds_read_b128 v[20:23], v13 offset:576
    ds_read2_b32 v[24:25], v12 offset0:0 offset1:1
    ds_read2_b32 v[26:27], v12 offset0:2 offset1:3
    ds_read_b128 v[28:31], v13 offset:3648
    ds_read2_b32 v[32:33], v12 offset0:24 offset1:25
    ds_read2_b32 v[34:35], v12 offset0:26 offset1:27
    ds_read_b128 v[36:39], v13 offset:560
    ds_read2_b32 v[40:41], v12 offset0:16 offset1:17
    ds_read2_b32 v[42:43], v12 offset0:18 offset1:19
    ds_read_b128 v[44:47], v13 offset:3632
mega_clpa:
    s_waitcnt lgkmcnt(0)
    ds_read2_b32 v[84:85], v12 offset0:40 offset1:41
    ds_read2_b32 v[86:87], v12 offset0:42 offset1:43
    ds_read_b128 v[88:91], v13 offset:544
    ds_read2_b32 v[92:93], v12 offset0:32 offset1:33
    ds_read2_b32 v[94:95], v12 offset0:34 offset1:35
    ds_read_b128 v[96:99], v13 offset:3616
    ds_read2_b32 v[100:101], v12 offset0:56 offset1:57
    ds_read2_b32 v[102:103], v12 offset0:58 offset1:59
    ds_read_b128 v[104:107], v13 offset:528
    ds_read2_b32 v[108:109], v12 offset0:48 offset1:49
    ds_read2_b32 v[110:111], v12 offset0:50 offset1:51
    ds_read_b128 v[112:115], v13 offset:3600
    v_mfma_f32_32x32x16_bf16 v[64:79], v[16:19], v[20:23], v[64:79]
    v_mfma_f32_32x32x16_bf16 v[64:79], v[24:27], v[28:31], v[64:79]
    v_mfma_f32_32x32x16_bf16 v[64:79], v[32:35], v[36:39], v[64:79]
    v_mfma_f32_32x32x16_bf16 v[64:79], v[40:43], v[44:47], v[64:79]
    s_waitcnt lgkmcnt(0)
    ds_read2_b32 v[16:17], v12 offset0:72 offset1:73
    ds_read2_b32 v[18:19], v12 offset0:74 offset1:75
    ds_read_b128 v[20:23], v13 offset:512
    ds_read2_b32 v[24:25], v12 offset0:64 offset1:65
    ds_read2_b32 v[26:27], v12 offset0:66 offset1:67
    ds_read_b128 v[28:31], v13 offset:3584
    ds_read2_b32 v[32:33], v12 offset0:88 offset1:89
    ds_read2_b32 v[34:35], v12 offset0:90 offset1:91
    ds_read_b128 v[36:39], v13 offset:496
    ds_read2_b32 v[40:41], v12 offset0:80 offset1:81
    ds_read2_b32 v[42:43], v12 offset0:82 offset1:83
    ds_read_b128 v[44:47], v13 offset:3568
    v_mfma_f32_32x32x16_bf16 v[64:79], v[84:87], v[88:91], v[64:79]
    v_mfma_f32_32x32x16_bf16 v[64:79], v[92:95], v[96:99], v[64:79]
    v_mfma_f32_32x32x16_bf16 v[64:79], v[100:103], v[104:107], v[64:79]
    v_mfma_f32_32x32x16_bf16 v[64:79], v[108:111], v[112:115], v[64:79]
    v_add_u32 v12, 256, v12
    v_subrev_u32 v13, 64, v13
    s_sub_u32 s55, s55, 1
    s_cmp_lg_u32 s55, 0
    s_cbranch_scc1 mega_clpa
    s_waitcnt lgkmcnt(0)

    s_lshl_b32 s52, s41, 12
    s_add_u32 s52, s52, 0
    v_add_u32 v9, s52, v3
    s_lshl_b32 s52, s41, 2
    v_add_u32 v10, s52, v4
    s_cmp_lg_u32 s42, 0
    s_cbranch_scc1 mega_cj1
    v_add_u32 v12, 1024, v12
    v_add_u32 v13, 256, v13
    s_mov_b32 s55, 4

    ds_read2_b32 v[16:17], v12 offset0:8 offset1:9
    ds_read2_b32 v[18:19], v12 offset0:10 offset1:11
    ds_read_b128 v[20:23], v13 offset:576
    ds_read2_b32 v[24:25], v12 offset0:0 offset1:1
    ds_read2_b32 v[26:27], v12 offset0:2 offset1:3
    ds_read_b128 v[28:31], v13 offset:3648
    ds_read2_b32 v[32:33], v12 offset0:24 offset1:25
    ds_read2_b32 v[34:35], v12 offset0:26 offset1:27
    ds_read_b128 v[36:39], v13 offset:560
    ds_read2_b32 v[40:41], v12 offset0:16 offset1:17
    ds_read2_b32 v[42:43], v12 offset0:18 offset1:19
    ds_read_b128 v[44:47], v13 offset:3632
mega_clpb:
    s_waitcnt lgkmcnt(0)
    ds_read2_b32 v[84:85], v12 offset0:40 offset1:41
    ds_read2_b32 v[86:87], v12 offset0:42 offset1:43
    ds_read_b128 v[88:91], v13 offset:544
    ds_read2_b32 v[92:93], v12 offset0:32 offset1:33
    ds_read2_b32 v[94:95], v12 offset0:34 offset1:35
    ds_read_b128 v[96:99], v13 offset:3616
    ds_read2_b32 v[100:101], v12 offset0:56 offset1:57
    ds_read2_b32 v[102:103], v12 offset0:58 offset1:59
    ds_read_b128 v[104:107], v13 offset:528
    ds_read2_b32 v[108:109], v12 offset0:48 offset1:49
    ds_read2_b32 v[110:111], v12 offset0:50 offset1:51
    ds_read_b128 v[112:115], v13 offset:3600
    v_mfma_f32_32x32x16_bf16 v[116:131], v[16:19], v[20:23], v[116:131]
    v_mfma_f32_32x32x16_bf16 v[116:131], v[24:27], v[28:31], v[116:131]
    v_mfma_f32_32x32x16_bf16 v[116:131], v[32:35], v[36:39], v[116:131]
    v_mfma_f32_32x32x16_bf16 v[116:131], v[40:43], v[44:47], v[116:131]
    s_waitcnt lgkmcnt(0)
    ds_read2_b32 v[16:17], v12 offset0:72 offset1:73
    ds_read2_b32 v[18:19], v12 offset0:74 offset1:75
    ds_read_b128 v[20:23], v13 offset:512
    ds_read2_b32 v[24:25], v12 offset0:64 offset1:65
    ds_read2_b32 v[26:27], v12 offset0:66 offset1:67
    ds_read_b128 v[28:31], v13 offset:3584
    ds_read2_b32 v[32:33], v12 offset0:88 offset1:89
    ds_read2_b32 v[34:35], v12 offset0:90 offset1:91
    ds_read_b128 v[36:39], v13 offset:496
    ds_read2_b32 v[40:41], v12 offset0:80 offset1:81
    ds_read2_b32 v[42:43], v12 offset0:82 offset1:83
    ds_read_b128 v[44:47], v13 offset:3568
    v_mfma_f32_32x32x16_bf16 v[116:131], v[84:87], v[88:91], v[116:131]
    v_mfma_f32_32x32x16_bf16 v[116:131], v[92:95], v[96:99], v[116:131]
    v_mfma_f32_32x32x16_bf16 v[116:131], v[100:103], v[104:107], v[116:131]
    v_mfma_f32_32x32x16_bf16 v[116:131], v[108:111], v[112:115], v[116:131]
    v_add_u32 v12, 256, v12
    v_subrev_u32 v13, 64, v13
    s_sub_u32 s55, s55, 1
    s_cmp_lg_u32 s55, 0
    s_cbranch_scc1 mega_clpb
    s_waitcnt lgkmcnt(0)

mega_cpg:
    ds_read_b32 v5, v4 offset:8
    s_waitcnt lgkmcnt(0)
    v_readfirstlane_b32 s52, v5
    s_cmp_ge_u32 s52, 8
    s_cbranch_scc1 mega_cpd
    s_sleep 4
    s_branch mega_cpg

mega_cpd:
    s_nop 7
    ds_write_b128 v9, v[116:119] offset:0
    ds_write_b128 v9, v[120:123] offset:1024
    ds_write_b128 v9, v[124:127] offset:2048
    ds_write_b128 v9, v[128:131] offset:3072
    v_mov_b32 v5, 1
    s_waitcnt lgkmcnt(0)
    s_mov_b64 exec, 1
    ds_write_b32 v10, v5 offset:12
    s_mov_b64 exec, -1
    s_branch mega_cjd

mega_cj1:
    ds_read_b32 v5, v10 offset:12
    s_waitcnt lgkmcnt(0)
    v_readfirstlane_b32 s52, v5
    s_cmp_lg_u32 s52, 0
    s_cbranch_scc1 mega_cj2
    s_sleep 1
    s_branch mega_cj1

mega_cj2:
    ds_read_b128 v[116:119], v9 offset:0
    ds_read_b128 v[120:123], v9 offset:1024
    ds_read_b128 v[124:127], v9 offset:2048
    ds_read_b128 v[128:131], v9 offset:3072
    s_waitcnt lgkmcnt(0)
    v_add_f32 v64, v64, v116
    v_add_f32 v65, v65, v117
    v_add_f32 v66, v66, v118
    v_add_f32 v67, v67, v119
    v_add_f32 v68, v68, v120
    v_add_f32 v69, v69, v121
    v_add_f32 v70, v70, v122
    v_add_f32 v71, v71, v123
    v_add_f32 v72, v72, v124
    v_add_f32 v73, v73, v125
    v_add_f32 v74, v74, v126
    v_add_f32 v75, v75, v127
    v_add_f32 v76, v76, v128
    v_add_f32 v77, v77, v129
    v_add_f32 v78, v78, v130
    v_add_f32 v79, v79, v131
mega_cjd:
    ds_read_b128 v[16:19], v8 offset:512
    ds_read_b128 v[20:23], v8 offset:3584
    s_lshl_b32 s60, s47, 16
    s_and_b32 s61, s47, 0xffff0000
    s_cmp_eq_u32 s41, 0
    s_cselect_b32 s60, s60, s61
    v_lshlrev_b32 v12, 4, v7
    v_lshl_add_u32 v12, v6, 10, v12
    s_lshl_b32 s59, s42, 9
    s_add_u32 s58, s59, s46
    s_add_u32 s58, s58, 0x1200000
    s_lshl_b32 s59, s42, 11
    s_waitcnt lgkmcnt(0)

    v_lshlrev_b32 v31, 16, v16
    v_and_b32 v30, 0xffff0000, v16
    v_lshlrev_b32 v29, 16, v17
    v_and_b32 v28, 0xffff0000, v17
    v_lshlrev_b32 v27, 16, v18
    v_and_b32 v26, 0xffff0000, v18
    v_lshlrev_b32 v25, 16, v19
    v_and_b32 v24, 0xffff0000, v19
    v_lshlrev_b32 v39, 16, v20
    v_and_b32 v38, 0xffff0000, v20
    v_lshlrev_b32 v37, 16, v21
    v_and_b32 v36, 0xffff0000, v21
    v_lshlrev_b32 v35, 16, v22
    v_and_b32 v34, 0xffff0000, v22
    v_lshlrev_b32 v33, 16, v23
    v_and_b32 v32, 0xffff0000, v23
    v_mul_f32 v24, s60, v24
    v_mul_f32 v25, s60, v25
    v_mul_f32 v26, s60, v26
    v_mul_f32 v27, s60, v27
    v_mul_f32 v28, s60, v28
    v_mul_f32 v29, s60, v29
    v_mul_f32 v30, s60, v30
    v_mul_f32 v31, s60, v31
    v_mul_f32 v32, s60, v32
    v_mul_f32 v33, s60, v33
    v_mul_f32 v34, s60, v34
    v_mul_f32 v35, s60, v35
    v_mul_f32 v36, s60, v36
    v_mul_f32 v37, s60, v37
    v_mul_f32 v38, s60, v38
    v_mul_f32 v39, s60, v39
    v_cvt_pk_bf16_f32 v16, v64, v65
    v_cvt_pk_bf16_f32 v40, v24, v25
    v_cvt_pk_bf16_f32 v17, v66, v67
    v_cvt_pk_bf16_f32 v41, v26, v27
    v_cvt_pk_bf16_f32 v18, v68, v69
    v_cvt_pk_bf16_f32 v42, v28, v29
    v_cvt_pk_bf16_f32 v19, v70, v71
    v_cvt_pk_bf16_f32 v43, v30, v31
    v_cvt_pk_bf16_f32 v20, v72, v73
    v_cvt_pk_bf16_f32 v44, v32, v33
    v_cvt_pk_bf16_f32 v21, v74, v75
    v_cvt_pk_bf16_f32 v45, v34, v35
    v_cvt_pk_bf16_f32 v22, v76, v77
    v_cvt_pk_bf16_f32 v46, v36, v37
    v_cvt_pk_bf16_f32 v23, v78, v79
    v_cvt_pk_bf16_f32 v47, v38, v39
    v_lshlrev_b32 v64, 16, v16
    v_and_b32 v65, 0xffff0000, v16
    v_lshlrev_b32 v24, 16, v40
    v_and_b32 v25, 0xffff0000, v40
    v_lshlrev_b32 v66, 16, v17
    v_and_b32 v67, 0xffff0000, v17
    v_lshlrev_b32 v26, 16, v41
    v_and_b32 v27, 0xffff0000, v41
    v_lshlrev_b32 v68, 16, v18
    v_and_b32 v69, 0xffff0000, v18
    v_lshlrev_b32 v28, 16, v42
    v_and_b32 v29, 0xffff0000, v42
    v_lshlrev_b32 v70, 16, v19
    v_and_b32 v71, 0xffff0000, v19
    v_lshlrev_b32 v30, 16, v43
    v_and_b32 v31, 0xffff0000, v43
    v_lshlrev_b32 v72, 16, v20
    v_and_b32 v73, 0xffff0000, v20
    v_lshlrev_b32 v32, 16, v44
    v_and_b32 v33, 0xffff0000, v44
    v_lshlrev_b32 v74, 16, v21
    v_and_b32 v75, 0xffff0000, v21
    v_lshlrev_b32 v34, 16, v45
    v_and_b32 v35, 0xffff0000, v45
    v_lshlrev_b32 v76, 16, v22
    v_and_b32 v77, 0xffff0000, v22
    v_lshlrev_b32 v36, 16, v46
    v_and_b32 v37, 0xffff0000, v46
    v_lshlrev_b32 v78, 16, v23
    v_and_b32 v79, 0xffff0000, v23
    v_lshlrev_b32 v38, 16, v47
    v_and_b32 v39, 0xffff0000, v47
    v_add_f32 v64, v64, v24
    v_add_f32 v65, v65, v25
    v_add_f32 v66, v66, v26
    v_add_f32 v67, v67, v27
    v_add_f32 v68, v68, v28
    v_add_f32 v69, v69, v29
    v_add_f32 v70, v70, v30
    v_add_f32 v71, v71, v31
    v_add_f32 v72, v72, v32
    v_add_f32 v73, v73, v33
    v_add_f32 v74, v74, v34
    v_add_f32 v75, v75, v35
    v_add_f32 v76, v76, v36
    v_add_f32 v77, v77, v37
    v_add_f32 v78, v78, v38
    v_add_f32 v79, v79, v39
    v_cvt_pk_bf16_f32 v16, v64, v65
    v_cvt_pk_bf16_f32 v17, v66, v67
    v_cvt_pk_bf16_f32 v18, v68, v69
    v_cvt_pk_bf16_f32 v19, v70, v71
    v_cvt_pk_bf16_f32 v20, v72, v73
    v_cvt_pk_bf16_f32 v21, v74, v75
    v_cvt_pk_bf16_f32 v22, v76, v77
    v_cvt_pk_bf16_f32 v23, v78, v79
    buffer_store_dwordx4 v[16:19], v12, s[24:27], s58 offen sc1
    buffer_store_dwordx4 v[20:23], v12, s[24:27], s58 offen offset:2048 sc1
    s_lshl_b32 s68, s43, 2
    s_add_u32 s68, s68, s59
    s_add_u32 s68, s68, 0x1564000

    v_mov_b32 v15, s65
    v_mov_b32 v14, 0
    s_waitcnt vmcnt(0)
    s_mov_b64 exec, 1
    buffer_store_dword v15, v14, s[24:27], s68 offen sc1
    s_mov_b64 exec, -1

    s_cmp_lg_u32 s39, 0
    s_cbranch_scc1 mega_nall
    s_mov_b32 s53, 0x1560000

    s_mov_b32 s53, 0x1561000
    s_mov_b32 s69, 0x10000
mega_fwy_45:
    buffer_load_dwordx4 v[16:19], v3, s[24:27], s53 offen offset:0 sc1
    buffer_load_dwordx4 v[20:23], v3, s[24:27], s53 offen offset:1024 sc1
    buffer_load_dwordx4 v[24:27], v3, s[24:27], s53 offen offset:2048 sc1
    buffer_load_dwordx4 v[28:31], v3, s[24:27], s53 offen offset:3072 sc1
    s_waitcnt vmcnt(0)
    v_xor_b32 v15, s65, v16
    v_xor_b32 v17, s65, v17
    v_or_b32 v15, v15, v17
    v_xor_b32 v18, s65, v18
    v_or_b32 v15, v15, v18
    v_xor_b32 v19, s65, v19
    v_or_b32 v15, v15, v19
    v_xor_b32 v20, s65, v20
    v_or_b32 v15, v15, v20
    v_xor_b32 v21, s65, v21
    v_or_b32 v15, v15, v21
    v_xor_b32 v22, s65, v22
    v_or_b32 v15, v15, v22
    v_xor_b32 v23, s65, v23
    v_or_b32 v15, v15, v23
    v_xor_b32 v24, s65, v24
    v_or_b32 v15, v15, v24
    v_xor_b32 v25, s65, v25
    v_or_b32 v15, v15, v25
    v_xor_b32 v26, s65, v26
    v_or_b32 v15, v15, v26
    v_xor_b32 v27, s65, v27
    v_or_b32 v15, v15, v27
    v_xor_b32 v28, s65, v28
    v_or_b32 v15, v15, v28
    v_xor_b32 v29, s65, v29
    v_or_b32 v15, v15, v29
    v_xor_b32 v30, s65, v30
    v_or_b32 v15, v15, v30
    v_xor_b32 v31, s65, v31
    v_or_b32 v15, v15, v31
    v_cmp_ne_u32 vcc, 0, v15
    s_cmp_eq_u64 vcc, 0
    s_cbranch_scc1 mega_fwy_45_d
    s_sub_u32 s69, s69, 1
    s_cbranch_scc1 mega_fwy_45_d
    s_sleep 2
    s_branch mega_fwy_45

mega_fwy_45_d:
mega_nall:
    v_mov_b32 v5, 1
    s_mov_b64 exec, 1
    ds_add_u32 v4, v5
    s_mov_b64 exec, -1

mega_cw2:
    ds_read_b32 v5, v4
    s_waitcnt lgkmcnt(0)
    v_readfirstlane_b32 s52, v5
    s_cmp_ge_u32 s52, 8
    s_cbranch_scc1 mega_cw3
    s_sleep 1
    s_branch mega_cw2

mega_cw3:
    v_lshlrev_b32 v80, 7, v1
    s_mul_i32 s53, s37, 49152
    s_mul_i32 s54, s39, 12288
    s_add_u32 s53, s53, s54
    s_add_u32 s53, s53, 0x1600000
    buffer_load_dword v81, v80, s[24:27], s53 offen
    s_add_u32 s53, s53, 4096
    buffer_load_dword v81, v80, s[24:27], s53 offen

mega_hend:
mega_wpb:
    ds_read_b32 v84, v4 offset:8
    s_waitcnt lgkmcnt(0)
    v_readfirstlane_b32 s52, v84
    s_cmp_ge_u32 s52, 8
    s_cbranch_scc1 mega_wqb
    s_sleep 8
    s_branch mega_wpb

mega_wqb:
    s_mov_b32 s20, s6
    s_mov_b32 s21, s7
    s_mov_b32 s22, 0x80000
    s_mov_b32 s23, 0x00020000
    v_bfe_u32 v84, v1, 2, 3
    v_lshlrev_b32 v84, 10, v84
    v_lshrrev_b32 v85, 5, v1
    v_lshl_add_u32 v84, v85, 6, v84
    v_and_b32 v85, 3, v1
    v_lshl_add_u32 v84, v85, 4, v84
    s_lshr_b32 s52, s37, 2
    s_lshl_b32 s52, s52, 7
    s_lshl_b32 s53, s39, 13
    s_add_u32 s52, s52, s53
    s_lshl_b32 s54, s39, 10

    s_add_u32 m0, s54, 0
    s_add_u32 s53, s52, 0
    buffer_load_dwordx4 v84, s[20:23], s53 offen lds
    s_add_u32 m0, s54, 4096
    s_add_u32 s53, s52, 32768
    buffer_load_dwordx4 v84, s[20:23], s53 offen lds
    s_add_u32 m0, s54, 8192
    s_add_u32 s53, s52, 65536
    buffer_load_dwordx4 v84, s[20:23], s53 offen lds
    s_add_u32 m0, s54, 12288
    s_add_u32 s53, s52, 98304
    buffer_load_dwordx4 v84, s[20:23], s53 offen lds
    s_add_u32 m0, s54, 32768
    s_add_u32 s53, s52, 131072
    buffer_load_dwordx4 v84, s[20:23], s53 offen lds
    s_add_u32 m0, s54, 36864
    s_add_u32 s53, s52, 163840
    buffer_load_dwordx4 v84, s[20:23], s53 offen lds
    s_add_u32 m0, s54, 40960
    s_add_u32 s53, s52, 196608
    buffer_load_dwordx4 v84, s[20:23], s53 offen lds
    s_add_u32 m0, s54, 45056
    s_add_u32 s53, s52, 229376
    buffer_load_dwordx4 v84, s[20:23], s53 offen lds
    s_add_u32 m0, s54, 65536
    s_add_u32 s53, s52, 262144
    buffer_load_dwordx4 v84, s[20:23], s53 offen lds
    s_add_u32 m0, s54, 69632
    s_add_u32 s53, s52, 294912
    buffer_load_dwordx4 v84, s[20:23], s53 offen lds
    s_add_u32 m0, s54, 73728
    s_add_u32 s53, s52, 327680
    buffer_load_dwordx4 v84, s[20:23], s53 offen lds
    s_add_u32 m0, s54, 77824
    s_add_u32 s53, s52, 360448
    buffer_load_dwordx4 v84, s[20:23], s53 offen lds
    s_add_u32 m0, s54, 98304
    s_add_u32 s53, s52, 393216
    buffer_load_dwordx4 v84, s[20:23], s53 offen lds
    s_add_u32 m0, s54, 102400
    s_add_u32 s53, s52, 425984
    buffer_load_dwordx4 v84, s[20:23], s53 offen lds
    s_add_u32 m0, s54, 106496
    s_add_u32 s53, s52, 458752
    buffer_load_dwordx4 v84, s[20:23], s53 offen lds
    s_add_u32 m0, s54, 110592
    s_add_u32 s53, s52, 491520
    buffer_load_dwordx4 v84, s[20:23], s53 offen lds
    s_setprio 0
    s_barrier
    s_barrier

mega_op:
    s_lshl_b32 s41, s36, 2
    s_and_b32 s46, s37, 3
    s_add_u32 s41, s41, s46
    s_lshr_b32 s42, s37, 2
    s_cmp_lt_u32 s40, 4
    s_cbranch_scc1 mega_opc
    s_cmp_lt_u32 s40, 8
    s_cbranch_scc1 mega_opb

mega_oph:
    s_sub_u32 s53, s40, 8
    s_and_b32 s55, s53, 1
    s_lshl_b32 s55, s55, 15
    s_lshr_b32 s56, s53, 1
    s_lshl_b32 s56, s56, 14
    s_add_u32 s55, s55, s56
    s_lshl_b32 s56, s41, 16
    s_add_u32 s56, s56, s55
    s_mul_i32 s57, s3, 0x200000
    s_add_u32 s56, s56, s57
    s_add_u32 s56, s56, 0xc00000
    s_add_u32 s57, s56, 4096
    s_add_u32 s58, s56, 8192
    s_add_u32 s59, s56, 12288
    s_and_b32 s55, s53, 1
    s_lshl_b32 s55, s55, 16
    s_lshr_b32 s54, s53, 1
    s_lshl_b32 s54, s54, 15
    s_add_u32 s55, s55, s54
    s_add_u32 s55, s55, 16384
    v_add_u32 v6, s55, v3

    v_lshlrev_b32 v14, 10, v1
    s_add_u32 s54, s56, 1020
    v_mov_b32 v7, v3
    s_mov_b32 s69, 0x8000
mega_hw_46:
    s_mov_b64 exec, 0xffff
    buffer_load_dword v15, v14, s[24:27], s54 offen sc1
    s_waitcnt vmcnt(0)
    v_cmp_eq_u32 vcc, -1, v15
    s_mov_b64 exec, -1
    s_bcnt1_i32_b64 s66, vcc
    s_cmp_le_u32 s66, 4
    s_cbranch_scc1 mega_hw_46_d
    s_sub_u32 s69, s69, 1
    s_cbranch_scc1 mega_hw_46_d

    s_sleep 1
    s_branch mega_hw_46

mega_hw_46_d:
    buffer_load_dwordx4 v[16:19], v7, s[24:27], s56 offen offset:0 sc1
    buffer_load_dwordx4 v[20:23], v7, s[24:27], s56 offen offset:1024 sc1
    buffer_load_dwordx4 v[24:27], v7, s[24:27], s56 offen offset:2048 sc1
    buffer_load_dwordx4 v[28:31], v7, s[24:27], s56 offen offset:3072 sc1
    buffer_load_dwordx4 v[32:35], v7, s[24:27], s57 offen offset:0 sc1
    buffer_load_dwordx4 v[36:39], v7, s[24:27], s57 offen offset:1024 sc1
    buffer_load_dwordx4 v[40:43], v7, s[24:27], s57 offen offset:2048 sc1
    buffer_load_dwordx4 v[44:47], v7, s[24:27], s57 offen offset:3072 sc1
    buffer_load_dwordx4 v[48:51], v7, s[24:27], s58 offen offset:0 sc1
    buffer_load_dwordx4 v[52:55], v7, s[24:27], s58 offen offset:1024 sc1
    buffer_load_dwordx4 v[56:59], v7, s[24:27], s58 offen offset:2048 sc1
    buffer_load_dwordx4 v[60:63], v7, s[24:27], s58 offen offset:3072 sc1
    buffer_load_dwordx4 v[64:67], v7, s[24:27], s59 offen offset:0 sc1
    buffer_load_dwordx4 v[68:71], v7, s[24:27], s59 offen offset:1024 sc1
    buffer_load_dwordx4 v[72:75], v7, s[24:27], s59 offen offset:2048 sc1
    buffer_load_dwordx4 v[76:79], v7, s[24:27], s59 offen offset:3072 sc1
    s_mov_b32 s69, 0x8000
    s_mov_b32 s66, 0xffff
    s_waitcnt vmcnt(0)
    v_max3_u32 v15, v16, v17, v18
    v_max3_u32 v15, v15, v19, v20
    v_max3_u32 v15, v15, v21, v22
    v_max3_u32 v15, v15, v23, v24
    v_max3_u32 v15, v15, v25, v26
    v_max3_u32 v15, v15, v27, v28
    v_max3_u32 v15, v15, v29, v30
    v_max3_u32 v15, v15, v31, v32
    v_max3_u32 v15, v15, v33, v34
    v_max3_u32 v15, v15, v35, v36
    v_max3_u32 v15, v15, v37, v38
    v_max3_u32 v15, v15, v39, v40
    v_max3_u32 v15, v15, v41, v42
    v_max3_u32 v15, v15, v43, v44
    v_max3_u32 v15, v15, v45, v46
    v_max3_u32 v15, v15, v47, v48
    v_max3_u32 v15, v15, v49, v50
    v_max3_u32 v15, v15, v51, v52
    v_max3_u32 v15, v15, v53, v54
    v_max3_u32 v15, v15, v55, v56
    v_max3_u32 v15, v15, v57, v58
    v_max3_u32 v15, v15, v59, v60
    v_max3_u32 v15, v15, v61, v62
    v_max3_u32 v15, v15, v63, v64
    v_max3_u32 v15, v15, v65, v66
    v_max3_u32 v15, v15, v67, v68
    v_max3_u32 v15, v15, v69, v70
    v_max3_u32 v15, v15, v71, v72
    v_max3_u32 v15, v15, v73, v74
    v_max3_u32 v15, v15, v75, v76
    v_max3_u32 v15, v15, v77, v78
    v_max_u32 v15, v15, v79
    v_cmp_eq_u32 vcc, -1, v15
    s_cmp_eq_u64 vcc, 0
    s_cbranch_scc0 mega_cu_47_c

    ds_write_b128 v6, v[16:19] offset:0
    ds_write_b128 v6, v[20:23] offset:1024
    ds_write_b128 v6, v[24:27] offset:2048
    ds_write_b128 v6, v[28:31] offset:3072
    ds_write_b128 v6, v[32:35] offset:4096
    ds_write_b128 v6, v[36:39] offset:5120
    ds_write_b128 v6, v[40:43] offset:6144
    ds_write_b128 v6, v[44:47] offset:7168
    ds_write_b128 v6, v[48:51] offset:8192
    ds_write_b128 v6, v[52:55] offset:9216
    ds_write_b128 v6, v[56:59] offset:10240
    ds_write_b128 v6, v[60:63] offset:11264
    ds_write_b128 v6, v[64:67] offset:12288
    ds_write_b128 v6, v[68:71] offset:13312
    ds_write_b128 v6, v[72:75] offset:14336
    ds_write_b128 v6, v[76:79] offset:15360
    s_branch mega_cu_47_d
mega_cu_47:
    s_bitcmp1_b32 s66, 0
    s_cbranch_scc0 mega_cu_47_l0
    buffer_load_dwordx4 v[16:19], v7, s[24:27], s56 offen offset:0 sc1
mega_cu_47_l0:
    s_bitcmp1_b32 s66, 1
    s_cbranch_scc0 mega_cu_47_l1
    buffer_load_dwordx4 v[20:23], v7, s[24:27], s56 offen offset:1024 sc1
mega_cu_47_l1:
    s_bitcmp1_b32 s66, 2
    s_cbranch_scc0 mega_cu_47_l2
    buffer_load_dwordx4 v[24:27], v7, s[24:27], s56 offen offset:2048 sc1
mega_cu_47_l2:
    s_bitcmp1_b32 s66, 3
    s_cbranch_scc0 mega_cu_47_l3
    buffer_load_dwordx4 v[28:31], v7, s[24:27], s56 offen offset:3072 sc1
mega_cu_47_l3:
    s_bitcmp1_b32 s66, 4
    s_cbranch_scc0 mega_cu_47_l4
    buffer_load_dwordx4 v[32:35], v7, s[24:27], s57 offen offset:0 sc1
mega_cu_47_l4:
    s_bitcmp1_b32 s66, 5
    s_cbranch_scc0 mega_cu_47_l5
    buffer_load_dwordx4 v[36:39], v7, s[24:27], s57 offen offset:1024 sc1
mega_cu_47_l5:
    s_bitcmp1_b32 s66, 6
    s_cbranch_scc0 mega_cu_47_l6
    buffer_load_dwordx4 v[40:43], v7, s[24:27], s57 offen offset:2048 sc1
mega_cu_47_l6:
    s_bitcmp1_b32 s66, 7
    s_cbranch_scc0 mega_cu_47_l7
    buffer_load_dwordx4 v[44:47], v7, s[24:27], s57 offen offset:3072 sc1
mega_cu_47_l7:
    s_bitcmp1_b32 s66, 8
    s_cbranch_scc0 mega_cu_47_l8
    buffer_load_dwordx4 v[48:51], v7, s[24:27], s58 offen offset:0 sc1
mega_cu_47_l8:
    s_bitcmp1_b32 s66, 9
    s_cbranch_scc0 mega_cu_47_l9
    buffer_load_dwordx4 v[52:55], v7, s[24:27], s58 offen offset:1024 sc1
mega_cu_47_l9:
    s_bitcmp1_b32 s66, 10
    s_cbranch_scc0 mega_cu_47_l10
    buffer_load_dwordx4 v[56:59], v7, s[24:27], s58 offen offset:2048 sc1
mega_cu_47_l10:
    s_bitcmp1_b32 s66, 11
    s_cbranch_scc0 mega_cu_47_l11
    buffer_load_dwordx4 v[60:63], v7, s[24:27], s58 offen offset:3072 sc1
mega_cu_47_l11:
    s_bitcmp1_b32 s66, 12
    s_cbranch_scc0 mega_cu_47_l12
    buffer_load_dwordx4 v[64:67], v7, s[24:27], s59 offen offset:0 sc1
mega_cu_47_l12:
    s_bitcmp1_b32 s66, 13
    s_cbranch_scc0 mega_cu_47_l13
    buffer_load_dwordx4 v[68:71], v7, s[24:27], s59 offen offset:1024 sc1
mega_cu_47_l13:
    s_bitcmp1_b32 s66, 14
    s_cbranch_scc0 mega_cu_47_l14
    buffer_load_dwordx4 v[72:75], v7, s[24:27], s59 offen offset:2048 sc1
mega_cu_47_l14:
    s_bitcmp1_b32 s66, 15
    s_cbranch_scc0 mega_cu_47_l15
    buffer_load_dwordx4 v[76:79], v7, s[24:27], s59 offen offset:3072 sc1
mega_cu_47_l15:
    s_waitcnt vmcnt(0)
mega_cu_47_c:
    s_bitcmp1_b32 s66, 0
    s_cbranch_scc0 mega_cu_47_k0
    v_max3_u32 v15, v16, v17, v18
    v_max_u32 v15, v15, v19
    v_cmp_eq_u32 vcc, -1, v15
    s_cmp_eq_u64 vcc, 0
    s_cbranch_scc0 mega_cu_47_k0
    s_bitset0_b32 s66, 0

    ds_write_b128 v6, v[16:19] offset:0
mega_cu_47_k0:
    s_bitcmp1_b32 s66, 1
    s_cbranch_scc0 mega_cu_47_k1
    v_max3_u32 v15, v20, v21, v22
    v_max_u32 v15, v15, v23
    v_cmp_eq_u32 vcc, -1, v15
    s_cmp_eq_u64 vcc, 0
    s_cbranch_scc0 mega_cu_47_k1
    s_bitset0_b32 s66, 1

    ds_write_b128 v6, v[20:23] offset:1024
mega_cu_47_k1:
    s_bitcmp1_b32 s66, 2
    s_cbranch_scc0 mega_cu_47_k2
    v_max3_u32 v15, v24, v25, v26
    v_max_u32 v15, v15, v27
    v_cmp_eq_u32 vcc, -1, v15
    s_cmp_eq_u64 vcc, 0
    s_cbranch_scc0 mega_cu_47_k2
    s_bitset0_b32 s66, 2

    ds_write_b128 v6, v[24:27] offset:2048
mega_cu_47_k2:
    s_bitcmp1_b32 s66, 3
    s_cbranch_scc0 mega_cu_47_k3
    v_max3_u32 v15, v28, v29, v30
    v_max_u32 v15, v15, v31
    v_cmp_eq_u32 vcc, -1, v15
    s_cmp_eq_u64 vcc, 0
    s_cbranch_scc0 mega_cu_47_k3
    s_bitset0_b32 s66, 3

    ds_write_b128 v6, v[28:31] offset:3072
mega_cu_47_k3:
    s_bitcmp1_b32 s66, 4
    s_cbranch_scc0 mega_cu_47_k4
    v_max3_u32 v15, v32, v33, v34
    v_max_u32 v15, v15, v35
    v_cmp_eq_u32 vcc, -1, v15
    s_cmp_eq_u64 vcc, 0
    s_cbranch_scc0 mega_cu_47_k4
    s_bitset0_b32 s66, 4

    ds_write_b128 v6, v[32:35] offset:4096
mega_cu_47_k4:
    s_bitcmp1_b32 s66, 5
    s_cbranch_scc0 mega_cu_47_k5
    v_max3_u32 v15, v36, v37, v38
    v_max_u32 v15, v15, v39
    v_cmp_eq_u32 vcc, -1, v15
    s_cmp_eq_u64 vcc, 0
    s_cbranch_scc0 mega_cu_47_k5
    s_bitset0_b32 s66, 5

    ds_write_b128 v6, v[36:39] offset:5120
mega_cu_47_k5:
    s_bitcmp1_b32 s66, 6
    s_cbranch_scc0 mega_cu_47_k6
    v_max3_u32 v15, v40, v41, v42
    v_max_u32 v15, v15, v43
    v_cmp_eq_u32 vcc, -1, v15
    s_cmp_eq_u64 vcc, 0
    s_cbranch_scc0 mega_cu_47_k6
    s_bitset0_b32 s66, 6

    ds_write_b128 v6, v[40:43] offset:6144
mega_cu_47_k6:
    s_bitcmp1_b32 s66, 7
    s_cbranch_scc0 mega_cu_47_k7
    v_max3_u32 v15, v44, v45, v46
    v_max_u32 v15, v15, v47
    v_cmp_eq_u32 vcc, -1, v15
    s_cmp_eq_u64 vcc, 0
    s_cbranch_scc0 mega_cu_47_k7
    s_bitset0_b32 s66, 7

    ds_write_b128 v6, v[44:47] offset:7168
mega_cu_47_k7:
    s_bitcmp1_b32 s66, 8
    s_cbranch_scc0 mega_cu_47_k8
    v_max3_u32 v15, v48, v49, v50
    v_max_u32 v15, v15, v51
    v_cmp_eq_u32 vcc, -1, v15
    s_cmp_eq_u64 vcc, 0
    s_cbranch_scc0 mega_cu_47_k8
    s_bitset0_b32 s66, 8

    ds_write_b128 v6, v[48:51] offset:8192
mega_cu_47_k8:
    s_bitcmp1_b32 s66, 9
    s_cbranch_scc0 mega_cu_47_k9
    v_max3_u32 v15, v52, v53, v54
    v_max_u32 v15, v15, v55
    v_cmp_eq_u32 vcc, -1, v15
    s_cmp_eq_u64 vcc, 0
    s_cbranch_scc0 mega_cu_47_k9
    s_bitset0_b32 s66, 9

    ds_write_b128 v6, v[52:55] offset:9216
mega_cu_47_k9:
    s_bitcmp1_b32 s66, 10
    s_cbranch_scc0 mega_cu_47_k10
    v_max3_u32 v15, v56, v57, v58
    v_max_u32 v15, v15, v59
    v_cmp_eq_u32 vcc, -1, v15
    s_cmp_eq_u64 vcc, 0
    s_cbranch_scc0 mega_cu_47_k10
    s_bitset0_b32 s66, 10

    ds_write_b128 v6, v[56:59] offset:10240
mega_cu_47_k10:
    s_bitcmp1_b32 s66, 11
    s_cbranch_scc0 mega_cu_47_k11
    v_max3_u32 v15, v60, v61, v62
    v_max_u32 v15, v15, v63
    v_cmp_eq_u32 vcc, -1, v15
    s_cmp_eq_u64 vcc, 0
    s_cbranch_scc0 mega_cu_47_k11
    s_bitset0_b32 s66, 11

    ds_write_b128 v6, v[60:63] offset:11264
mega_cu_47_k11:
    s_bitcmp1_b32 s66, 12
    s_cbranch_scc0 mega_cu_47_k12
    v_max3_u32 v15, v64, v65, v66
    v_max_u32 v15, v15, v67
    v_cmp_eq_u32 vcc, -1, v15
    s_cmp_eq_u64 vcc, 0
    s_cbranch_scc0 mega_cu_47_k12
    s_bitset0_b32 s66, 12

    ds_write_b128 v6, v[64:67] offset:12288
mega_cu_47_k12:
    s_bitcmp1_b32 s66, 13
    s_cbranch_scc0 mega_cu_47_k13
    v_max3_u32 v15, v68, v69, v70
    v_max_u32 v15, v15, v71
    v_cmp_eq_u32 vcc, -1, v15
    s_cmp_eq_u64 vcc, 0
    s_cbranch_scc0 mega_cu_47_k13
    s_bitset0_b32 s66, 13

    ds_write_b128 v6, v[68:71] offset:13312
mega_cu_47_k13:
    s_bitcmp1_b32 s66, 14
    s_cbranch_scc0 mega_cu_47_k14
    v_max3_u32 v15, v72, v73, v74
    v_max_u32 v15, v15, v75
    v_cmp_eq_u32 vcc, -1, v15
    s_cmp_eq_u64 vcc, 0
    s_cbranch_scc0 mega_cu_47_k14
    s_bitset0_b32 s66, 14

    ds_write_b128 v6, v[72:75] offset:14336
mega_cu_47_k14:
    s_bitcmp1_b32 s66, 15
    s_cbranch_scc0 mega_cu_47_k15
    v_max3_u32 v15, v76, v77, v78
    v_max_u32 v15, v15, v79
    v_cmp_eq_u32 vcc, -1, v15
    s_cmp_eq_u64 vcc, 0
    s_cbranch_scc0 mega_cu_47_k15
    s_bitset0_b32 s66, 15

    ds_write_b128 v6, v[76:79] offset:15360
mega_cu_47_k15:
    s_cmp_eq_u32 s66, 0
    s_cbranch_scc1 mega_cu_47_d
    s_sub_u32 s69, s69, 1
    s_cbranch_scc1 mega_cu_47_d

    s_sleep 1
    s_branch mega_cu_47

mega_cu_47_d:
    s_branch mega_opj
mega_opb:
    s_cmp_lg_u32 s40, 4
    s_cbranch_scc1 mega_opj

    s_cmp_lg_u32 s3, 0
    s_cbranch_scc1 mega_ygo
    s_lshr_b32 s53, s41, 4
    s_lshl_b32 s53, s53, 11
    s_lshl_b32 s55, s42, 8
    s_add_u32 s53, s53, s55
    s_add_u32 s53, s53, 0x1564000

    s_mov_b32 s69, 0x10000
mega_fww_48:
    buffer_load_dword v16, v2, s[24:27], s53 offen offset:0 sc1
    s_waitcnt vmcnt(0)
    v_xor_b32 v15, s65, v16
    v_cmp_ne_u32 vcc, 0, v15
    s_cmp_eq_u64 vcc, 0
    s_cbranch_scc1 mega_fww_48_d
    s_sub_u32 s69, s69, 1
    s_cbranch_scc1 mega_fww_48_d
    s_sleep 2
    s_branch mega_fww_48

mega_fww_48_d:
mega_ygo:
    v_lshrrev_b32 v5, 3, v1
    v_lshlrev_b32 v5, 12, v5
    v_and_b32 v6, 3, v1
    v_lshl_add_u32 v5, v6, 10, v5
    v_bfe_u32 v6, v1, 2, 1
    v_lshl_add_u32 v5, v6, 4, v5
    s_lshl_b32 s55, s42, 18
    s_lshl_b32 s56, s41, 5
    s_add_u32 s55, s55, s56

    s_mov_b32 m0, 151552
    s_add_u32 s56, s55, 0x1200000
    buffer_load_dwordx4 v5, s[24:27], s56 offen sc1 lds
    s_mov_b32 m0, 152576
    s_add_u32 s56, s55, 0x1208000
    buffer_load_dwordx4 v5, s[24:27], s56 offen sc1 lds
    s_mov_b32 m0, 153600
    s_add_u32 s56, s55, 0x1210000
    buffer_load_dwordx4 v5, s[24:27], s56 offen sc1 lds
    s_mov_b32 m0, 154624
    s_add_u32 s56, s55, 0x1218000
    buffer_load_dwordx4 v5, s[24:27], s56 offen sc1 lds
    s_mov_b32 m0, 155648
    s_add_u32 s56, s55, 0x1220000
    buffer_load_dwordx4 v5, s[24:27], s56 offen sc1 lds
    s_mov_b32 m0, 156672
    s_add_u32 s56, s55, 0x1228000
    buffer_load_dwordx4 v5, s[24:27], s56 offen sc1 lds
    s_mov_b32 m0, 157696
    s_add_u32 s56, s55, 0x1230000
    buffer_load_dwordx4 v5, s[24:27], s56 offen sc1 lds
    s_mov_b32 m0, 158720
    s_add_u32 s56, s55, 0x1238000
    buffer_load_dwordx4 v5, s[24:27], s56 offen sc1 lds
    s_waitcnt vmcnt(0)
mega_opj:
    s_waitcnt lgkmcnt(0)
    s_barrier

mega_opw:
    s_barrier
    s_cmp_lg_u32 s3, 0
    s_cbranch_scc1 mega_done
    s_branch mega_qkv

mega_opc:
    s_and_b32 s46, s40, 1
    s_lshr_b32 s47, s40, 1
    s_lshl_b32 s43, s41, 1
    s_add_u32 s43, s43, s46
    v_and_b32 v7, 31, v1
    v_lshlrev_b32 v8, 4, v7
    v_lshlrev_b32 v7, 10, v7
    v_lshrrev_b32 v6, 5, v1
    v_lshl_add_u32 v7, v6, 4, v7
    s_lshl_b32 s58, s43, 15
    s_lshl_b32 s56, s42, 7
    s_add_u32 s58, s58, s56
    s_lshl_b32 s56, s47, 6
    s_add_u32 s58, s58, s56
    s_lshl_b32 s55, s43, 15
    s_lshl_b32 s56, s42, 12
    s_add_u32 s55, s55, s56
    s_lshl_b32 s56, s47, 11
    s_add_u32 s55, s55, s56
    s_add_u32 s55, s55, 0x1000000
    s_mov_b32 s22, 0x200000
    s_mov_b32 s23, 0x00020000
    s_cmp_lg_u32 s3, 0
    s_cbranch_scc1 mega_opr1
    s_mov_b32 s20, s4
    s_mov_b32 s21, s5
    buffer_load_dwordx4 v[16:19], v7, s[20:23], s58 offen
    buffer_load_dwordx4 v[20:23], v7, s[20:23], s58 offen offset:32
    s_branch mega_opr2

mega_opr1:
    s_mov_b32 s20, s8
    s_mov_b32 s21, s9
    buffer_load_dwordx4 v[16:19], v3, s[24:27], s55 offen sc1
    buffer_load_dwordx4 v[20:23], v3, s[24:27], s55 offen offset:1024 sc1

mega_opr2:
    v_bfe_u32 v10, v1, 2, 2
    v_lshlrev_b32 v5, 10, v6
    v_lshl_add_u32 v4, v10, 7, v5
    v_lshl_add_u32 v5, v10, 6, v5
    v_bfe_u32 v10, v1, 4, 1
    v_lshl_add_u32 v5, v10, 5, v5
    v_lshl_add_u32 v4, v10, 5, v4
    v_and_b32 v10, 3, v1
    v_lshl_add_u32 v4, v10, 3, v4
    v_and_b32 v10, 1, v1
    v_lshl_add_u32 v5, v10, 4, v5
    v_bfe_u32 v10, v1, 1, 1
    v_lshl_add_u32 v5, v10, 3, v5
    s_lshl_b32 s57, s47, 9
    v_add_u32 v5, s57, v5
    s_lshl_b32 s57, s47, 12
    s_lshl_b32 s56, s46, 6
    s_add_u32 s57, s57, s56
    s_add_u32 s57, s57, 151552
    v_add_u32 v4, s57, v4
    s_lshl_b32 s57, s46, 16
    s_add_u32 s57, s57, 16384
    v_add_u32 v9, s57, v3
    v_add_u32 v11, 0x10000, v5
    s_mul_i32 s59, s3, 0x80000
    s_lshl_b32 s60, s43, 13
    s_add_u32 s59, s59, s60
    s_add_u32 s59, s59, 0x1400000
    s_lshl_b32 s60, s42, 10
    s_lshl_b32 s61, s47, 9
    s_add_u32 s60, s60, s61
    s_add_u32 s60, s60, s59
    s_add_u32 s61, s59, 4096
    s_mov_b32 s62, 0x3f803f80
    s_barrier

    ds_read_b128 v[48:51], v9 offset:0
    ds_read_b64_tr_b16 v[52:53], v5 offset:0
    ds_read_b64_tr_b16 v[54:55], v5 offset:256
    ds_read_b128 v[56:59], v9 offset:1024
    ds_read_b64_tr_b16 v[60:61], v5 offset:2048
    ds_read_b64_tr_b16 v[62:63], v5 offset:2304
    ds_read_b128 v[64:67], v9 offset:2048
    ds_read_b64_tr_b16 v[68:69], v5 offset:4096
    ds_read_b64_tr_b16 v[70:71], v5 offset:4352
    ds_read_b128 v[72:75], v9 offset:3072
    ds_read_b64_tr_b16 v[76:77], v5 offset:6144
    ds_read_b64_tr_b16 v[78:79], v5 offset:6400
    s_waitcnt lgkmcnt(9)
    v_mfma_f32_32x32x16_bf16 v[32:47], v[52:55], v[48:51], 0
    ds_read_b128 v[48:51], v9 offset:4096
    ds_read_b64_tr_b16 v[52:53], v5 offset:8192
    ds_read_b64_tr_b16 v[54:55], v5 offset:8448
    s_waitcnt lgkmcnt(9)
    v_mfma_f32_32x32x16_bf16 v[32:47], v[60:63], v[56:59], v[32:47]
    ds_read_b128 v[56:59], v9 offset:5120
    ds_read_b64_tr_b16 v[60:61], v5 offset:10240
    ds_read_b64_tr_b16 v[62:63], v5 offset:10496
    s_waitcnt lgkmcnt(9)
    v_mfma_f32_32x32x16_bf16 v[32:47], v[68:71], v[64:67], v[32:47]
    ds_read_b128 v[64:67], v9 offset:6144
    ds_read_b64_tr_b16 v[68:69], v5 offset:12288
    ds_read_b64_tr_b16 v[70:71], v5 offset:12544
    s_waitcnt lgkmcnt(9)
    v_mfma_f32_32x32x16_bf16 v[32:47], v[76:79], v[72:75], v[32:47]
    ds_read_b128 v[72:75], v9 offset:7168
    ds_read_b64_tr_b16 v[76:77], v5 offset:14336
    ds_read_b64_tr_b16 v[78:79], v5 offset:14592
    s_waitcnt lgkmcnt(9)
    v_mfma_f32_32x32x16_bf16 v[32:47], v[52:55], v[48:51], v[32:47]
    ds_read_b128 v[48:51], v9 offset:8192
    ds_read_b64_tr_b16 v[52:53], v5 offset:32768
    ds_read_b64_tr_b16 v[54:55], v5 offset:33024
    s_waitcnt lgkmcnt(9)
    v_mfma_f32_32x32x16_bf16 v[32:47], v[60:63], v[56:59], v[32:47]
    ds_read_b128 v[56:59], v9 offset:9216
    ds_read_b64_tr_b16 v[60:61], v5 offset:34816
    ds_read_b64_tr_b16 v[62:63], v5 offset:35072
    s_waitcnt lgkmcnt(9)
    v_mfma_f32_32x32x16_bf16 v[32:47], v[68:71], v[64:67], v[32:47]
    ds_read_b128 v[64:67], v9 offset:10240
    ds_read_b64_tr_b16 v[68:69], v5 offset:36864
    ds_read_b64_tr_b16 v[70:71], v5 offset:37120
    s_waitcnt lgkmcnt(9)
    v_mfma_f32_32x32x16_bf16 v[32:47], v[76:79], v[72:75], v[32:47]
    ds_read_b128 v[72:75], v9 offset:11264
    ds_read_b64_tr_b16 v[76:77], v5 offset:38912
    ds_read_b64_tr_b16 v[78:79], v5 offset:39168
    s_waitcnt lgkmcnt(9)
    v_mfma_f32_32x32x16_bf16 v[32:47], v[52:55], v[48:51], v[32:47]
    ds_read_b128 v[48:51], v9 offset:12288
    ds_read_b64_tr_b16 v[52:53], v5 offset:40960
    ds_read_b64_tr_b16 v[54:55], v5 offset:41216
    s_waitcnt lgkmcnt(9)
    v_mfma_f32_32x32x16_bf16 v[32:47], v[60:63], v[56:59], v[32:47]
    ds_read_b128 v[56:59], v9 offset:13312
    ds_read_b64_tr_b16 v[60:61], v5 offset:43008
    ds_read_b64_tr_b16 v[62:63], v5 offset:43264
    s_waitcnt lgkmcnt(9)
    v_mfma_f32_32x32x16_bf16 v[32:47], v[68:71], v[64:67], v[32:47]
    ds_read_b128 v[64:67], v9 offset:14336
    ds_read_b64_tr_b16 v[68:69], v5 offset:45056
    ds_read_b64_tr_b16 v[70:71], v5 offset:45312
    s_waitcnt lgkmcnt(9)
    v_mfma_f32_32x32x16_bf16 v[32:47], v[76:79], v[72:75], v[32:47]
    ds_read_b128 v[72:75], v9 offset:15360
    ds_read_b64_tr_b16 v[76:77], v5 offset:47104
    ds_read_b64_tr_b16 v[78:79], v5 offset:47360
    s_waitcnt lgkmcnt(9)
    v_mfma_f32_32x32x16_bf16 v[32:47], v[52:55], v[48:51], v[32:47]
    ds_read_b128 v[48:51], v9 offset:32768
    ds_read_b64_tr_b16 v[52:53], v11 offset:0
    ds_read_b64_tr_b16 v[54:55], v11 offset:256
    s_waitcnt lgkmcnt(9)
    v_mfma_f32_32x32x16_bf16 v[32:47], v[60:63], v[56:59], v[32:47]
    ds_read_b128 v[56:59], v9 offset:33792
    ds_read_b64_tr_b16 v[60:61], v11 offset:2048
    ds_read_b64_tr_b16 v[62:63], v11 offset:2304
    s_waitcnt lgkmcnt(9)
    v_mfma_f32_32x32x16_bf16 v[32:47], v[68:71], v[64:67], v[32:47]
    ds_read_b128 v[64:67], v9 offset:34816
    ds_read_b64_tr_b16 v[68:69], v11 offset:4096
    ds_read_b64_tr_b16 v[70:71], v11 offset:4352
    s_waitcnt lgkmcnt(9)
    v_mfma_f32_32x32x16_bf16 v[32:47], v[76:79], v[72:75], v[32:47]
    ds_read_b128 v[72:75], v9 offset:35840
    ds_read_b64_tr_b16 v[76:77], v11 offset:6144
    ds_read_b64_tr_b16 v[78:79], v11 offset:6400
    s_waitcnt lgkmcnt(9)
    v_mfma_f32_32x32x16_bf16 v[32:47], v[52:55], v[48:51], v[32:47]
    ds_read_b128 v[48:51], v9 offset:36864
    ds_read_b64_tr_b16 v[52:53], v11 offset:8192
    ds_read_b64_tr_b16 v[54:55], v11 offset:8448
    s_waitcnt lgkmcnt(9)
    v_mfma_f32_32x32x16_bf16 v[32:47], v[60:63], v[56:59], v[32:47]
    ds_read_b128 v[56:59], v9 offset:37888
    ds_read_b64_tr_b16 v[60:61], v11 offset:10240
    ds_read_b64_tr_b16 v[62:63], v11 offset:10496
    s_waitcnt lgkmcnt(9)
    v_mfma_f32_32x32x16_bf16 v[32:47], v[68:71], v[64:67], v[32:47]
    ds_read_b128 v[64:67], v9 offset:38912
    ds_read_b64_tr_b16 v[68:69], v11 offset:12288
    ds_read_b64_tr_b16 v[70:71], v11 offset:12544
    s_waitcnt lgkmcnt(9)
    v_mfma_f32_32x32x16_bf16 v[32:47], v[76:79], v[72:75], v[32:47]
    ds_read_b128 v[72:75], v9 offset:39936
    ds_read_b64_tr_b16 v[76:77], v11 offset:14336
    ds_read_b64_tr_b16 v[78:79], v11 offset:14592
    s_waitcnt lgkmcnt(9)
    v_mfma_f32_32x32x16_bf16 v[32:47], v[52:55], v[48:51], v[32:47]
    ds_read_b128 v[48:51], v9 offset:40960
    ds_read_b64_tr_b16 v[52:53], v11 offset:32768
    ds_read_b64_tr_b16 v[54:55], v11 offset:33024
    s_waitcnt lgkmcnt(9)
    v_mfma_f32_32x32x16_bf16 v[32:47], v[60:63], v[56:59], v[32:47]
    ds_read_b128 v[56:59], v9 offset:41984
    ds_read_b64_tr_b16 v[60:61], v11 offset:34816
    ds_read_b64_tr_b16 v[62:63], v11 offset:35072
    s_waitcnt lgkmcnt(9)
    v_mfma_f32_32x32x16_bf16 v[32:47], v[68:71], v[64:67], v[32:47]
    ds_read_b128 v[64:67], v9 offset:43008
    ds_read_b64_tr_b16 v[68:69], v11 offset:36864
    ds_read_b64_tr_b16 v[70:71], v11 offset:37120
    s_waitcnt lgkmcnt(9)
    v_mfma_f32_32x32x16_bf16 v[32:47], v[76:79], v[72:75], v[32:47]
    ds_read_b128 v[72:75], v9 offset:44032
    ds_read_b64_tr_b16 v[76:77], v11 offset:38912
    ds_read_b64_tr_b16 v[78:79], v11 offset:39168
    s_waitcnt lgkmcnt(9)
    v_mfma_f32_32x32x16_bf16 v[32:47], v[52:55], v[48:51], v[32:47]
    ds_read_b128 v[48:51], v9 offset:45056
    ds_read_b64_tr_b16 v[52:53], v11 offset:40960
    ds_read_b64_tr_b16 v[54:55], v11 offset:41216
    s_waitcnt lgkmcnt(9)
    v_mfma_f32_32x32x16_bf16 v[32:47], v[60:63], v[56:59], v[32:47]
    ds_read_b128 v[56:59], v9 offset:46080
    ds_read_b64_tr_b16 v[60:61], v11 offset:43008
    ds_read_b64_tr_b16 v[62:63], v11 offset:43264
    s_waitcnt lgkmcnt(9)
    v_mfma_f32_32x32x16_bf16 v[32:47], v[68:71], v[64:67], v[32:47]
    ds_read_b128 v[64:67], v9 offset:47104
    ds_read_b64_tr_b16 v[68:69], v11 offset:45056
    ds_read_b64_tr_b16 v[70:71], v11 offset:45312
    s_waitcnt lgkmcnt(9)
    v_mfma_f32_32x32x16_bf16 v[32:47], v[76:79], v[72:75], v[32:47]
    ds_read_b128 v[72:75], v9 offset:48128
    ds_read_b64_tr_b16 v[76:77], v11 offset:47104
    ds_read_b64_tr_b16 v[78:79], v11 offset:47360
    s_waitcnt lgkmcnt(9)
    v_mfma_f32_32x32x16_bf16 v[32:47], v[52:55], v[48:51], v[32:47]
    s_waitcnt lgkmcnt(6)
    v_mfma_f32_32x32x16_bf16 v[32:47], v[60:63], v[56:59], v[32:47]
    s_waitcnt lgkmcnt(3)
    v_mfma_f32_32x32x16_bf16 v[32:47], v[68:71], v[64:67], v[32:47]
    s_waitcnt lgkmcnt(0)
    v_mfma_f32_32x32x16_bf16 v[32:47], v[76:79], v[72:75], v[32:47]
    ds_read_b64_tr_b16 v[24:25], v4 offset:0
    ds_read_b64_tr_b16 v[26:27], v4 offset:512
    ds_read_b64_tr_b16 v[28:29], v4 offset:2048
    ds_read_b64_tr_b16 v[30:31], v4 offset:2560
    s_barrier
    s_waitcnt vmcnt(0)
    v_lshlrev_b32 v88, 16, v16
    v_and_b32 v89, 0xffff0000, v16
    v_lshlrev_b32 v90, 16, v17
    v_and_b32 v91, 0xffff0000, v17
    v_lshlrev_b32 v92, 16, v18
    v_and_b32 v93, 0xffff0000, v18
    v_lshlrev_b32 v94, 16, v19
    v_and_b32 v95, 0xffff0000, v19
    v_lshlrev_b32 v96, 16, v20
    v_and_b32 v97, 0xffff0000, v20
    v_lshlrev_b32 v98, 16, v21
    v_and_b32 v99, 0xffff0000, v21
    v_lshlrev_b32 v100, 16, v22
    v_and_b32 v101, 0xffff0000, v22
    v_lshlrev_b32 v102, 16, v23
    v_and_b32 v103, 0xffff0000, v23
    v_mov_b32 v12, 0
    v_mov_b32 v14, 0

    v_cvt_pk_bf16_f32 v80, v32, v33
    v_cvt_pk_bf16_f32 v81, v34, v35
    v_cvt_pk_bf16_f32 v82, v36, v37
    v_cvt_pk_bf16_f32 v83, v38, v39
    v_cvt_pk_bf16_f32 v84, v40, v41
    v_cvt_pk_bf16_f32 v85, v42, v43
    v_cvt_pk_bf16_f32 v86, v44, v45
    v_cvt_pk_bf16_f32 v87, v46, v47
    v_lshlrev_b32 v32, 16, v80
    v_and_b32 v33, 0xffff0000, v80
    v_lshlrev_b32 v34, 16, v81
    v_and_b32 v35, 0xffff0000, v81
    v_lshlrev_b32 v36, 16, v82
    v_and_b32 v37, 0xffff0000, v82
    v_lshlrev_b32 v38, 16, v83
    v_and_b32 v39, 0xffff0000, v83
    v_lshlrev_b32 v40, 16, v84
    v_and_b32 v41, 0xffff0000, v84
    v_lshlrev_b32 v42, 16, v85
    v_and_b32 v43, 0xffff0000, v85
    v_lshlrev_b32 v44, 16, v86
    v_and_b32 v45, 0xffff0000, v86
    v_lshlrev_b32 v46, 16, v87
    v_and_b32 v47, 0xffff0000, v87
    v_pk_add_f32 v[32:33], v[32:33], v[88:89]
    v_pk_add_f32 v[34:35], v[34:35], v[90:91]
    v_pk_add_f32 v[36:37], v[36:37], v[92:93]
    v_pk_add_f32 v[38:39], v[38:39], v[94:95]
    v_pk_add_f32 v[40:41], v[40:41], v[96:97]
    v_pk_add_f32 v[42:43], v[42:43], v[98:99]
    v_pk_add_f32 v[44:45], v[44:45], v[100:101]
    v_pk_add_f32 v[46:47], v[46:47], v[102:103]
    v_cvt_pk_bf16_f32 v80, v32, v33
    v_cvt_pk_bf16_f32 v81, v34, v35
    v_cvt_pk_bf16_f32 v82, v36, v37
    v_cvt_pk_bf16_f32 v83, v38, v39
    v_cvt_pk_bf16_f32 v84, v40, v41
    v_cvt_pk_bf16_f32 v85, v42, v43
    v_cvt_pk_bf16_f32 v86, v44, v45
    v_cvt_pk_bf16_f32 v87, v46, v47
    v_dot2c_f32_bf16 v12, s62, v80
    v_dot2c_f32_bf16 v14, v80, v80
    v_dot2c_f32_bf16 v12, s62, v81
    v_dot2c_f32_bf16 v14, v81, v81
    v_dot2c_f32_bf16 v12, s62, v82
    v_dot2c_f32_bf16 v14, v82, v82
    v_dot2c_f32_bf16 v12, s62, v83
    v_dot2c_f32_bf16 v14, v83, v83
    v_dot2c_f32_bf16 v12, s62, v84
    v_dot2c_f32_bf16 v14, v84, v84
    v_dot2c_f32_bf16 v12, s62, v85
    v_dot2c_f32_bf16 v14, v85, v85
    v_dot2c_f32_bf16 v12, s62, v86
    v_dot2c_f32_bf16 v14, v86, v86
    v_dot2c_f32_bf16 v12, s62, v87
    v_dot2c_f32_bf16 v14, v87, v87
    s_nop 2
    v_mov_b32 v13, v12
    v_mov_b32 v15, v14
    s_nop 1
    v_permlane32_swap_b32 v12, v13
    v_permlane32_swap_b32 v14, v15
    s_nop 1
    v_add_f32 v12, v12, v13
    v_add_f32 v14, v14, v15
    v_mov_b32 v13, s65
    v_mov_b32 v15, s65
    s_mov_b64 exec, 0xffffffff
    buffer_store_dwordx4 v[12:15], v8, s[24:27], s60 offen
    s_add_u32 s66, s60, 0x1000000
    buffer_store_dwordx4 v[12:15], v8, s[24:27], s66 offen sc1
    s_mov_b64 exec, -1
    s_mov_b32 s69, 0x8000
    v_mov_b32 v6, v3

    v_lshlrev_b32 v32, 16, v80
    v_and_b32 v33, 0xffff0000, v80
    v_lshlrev_b32 v34, 16, v81
    v_and_b32 v35, 0xffff0000, v81
    v_lshlrev_b32 v36, 16, v82
    v_and_b32 v37, 0xffff0000, v82
    v_lshlrev_b32 v38, 16, v83
    v_and_b32 v39, 0xffff0000, v83
    v_lshlrev_b32 v40, 16, v84
    v_and_b32 v41, 0xffff0000, v84
    v_lshlrev_b32 v42, 16, v85
    v_and_b32 v43, 0xffff0000, v85
    v_lshlrev_b32 v44, 16, v86
    v_and_b32 v45, 0xffff0000, v86
    v_lshlrev_b32 v46, 16, v87
    v_and_b32 v47, 0xffff0000, v87
    s_waitcnt lgkmcnt(0)
    v_lshlrev_b32 v88, 16, v24
    v_and_b32 v89, 0xffff0000, v24
    v_lshlrev_b32 v90, 16, v25
    v_and_b32 v91, 0xffff0000, v25
    v_lshlrev_b32 v92, 16, v26
    v_and_b32 v93, 0xffff0000, v26
    v_lshlrev_b32 v94, 16, v27
    v_and_b32 v95, 0xffff0000, v27
    v_lshlrev_b32 v96, 16, v28
    v_and_b32 v97, 0xffff0000, v28
    v_lshlrev_b32 v98, 16, v29
    v_and_b32 v99, 0xffff0000, v29
    v_lshlrev_b32 v100, 16, v30
    v_and_b32 v101, 0xffff0000, v30
    v_lshlrev_b32 v102, 16, v31
    v_and_b32 v103, 0xffff0000, v31
mega_gp:
    buffer_load_dwordx4 v[104:107], v6, s[24:27], s59 offen offset:0 sc1
    buffer_load_dwordx4 v[108:111], v6, s[24:27], s59 offen offset:1024 sc1
    buffer_load_dwordx4 v[112:115], v6, s[24:27], s59 offen offset:2048 sc1
    buffer_load_dwordx4 v[116:119], v6, s[24:27], s59 offen offset:3072 sc1
    buffer_load_dwordx4 v[120:123], v6, s[24:27], s61 offen offset:0 sc1
    buffer_load_dwordx4 v[124:127], v6, s[24:27], s61 offen offset:1024 sc1
    buffer_load_dwordx4 v[128:131], v6, s[24:27], s61 offen offset:2048 sc1
    buffer_load_dwordx4 v[132:135], v6, s[24:27], s61 offen offset:3072 sc1
    s_waitcnt vmcnt(0)
    v_min3_u32 v10, v105, v107, v109
    v_max3_u32 v11, v105, v107, v109
    v_min3_u32 v10, v10, v111, v113
    v_max3_u32 v11, v11, v111, v113
    v_min3_u32 v10, v10, v115, v117
    v_max3_u32 v11, v11, v115, v117
    v_min3_u32 v10, v10, v119, v121
    v_max3_u32 v11, v11, v119, v121
    v_min3_u32 v10, v10, v123, v125
    v_max3_u32 v11, v11, v123, v125
    v_min3_u32 v10, v10, v127, v129
    v_max3_u32 v11, v11, v127, v129
    v_min3_u32 v10, v10, v131, v133
    v_max3_u32 v11, v11, v131, v133
    v_min_u32 v10, v10, v135
    v_max_u32 v11, v11, v135
    v_xor_b32 v10, s65, v10
    v_xor_b32 v11, s65, v11
    v_or_b32 v10, v10, v11
    v_cmp_eq_u32 vcc, 0, v10
    s_sub_u32 s69, s69, 1
    s_cbranch_scc1 mega_gpo
    s_cmp_eq_u64 vcc, -1
    s_cbranch_scc1 mega_gpo

    s_cmp_lg_u32 s69, 32744
    s_cbranch_scc1 mega_gp_ns

    v_or_b32 v6, 0x1000000, v6
mega_gp_ns:
    s_sleep 2
    s_branch mega_gp

mega_gpo:
    v_add_f32 v104, v104, v108
    v_add_f32 v106, v106, v110
    v_add_f32 v104, v104, v112
    v_add_f32 v106, v106, v114
    v_add_f32 v104, v104, v116
    v_add_f32 v106, v106, v118
    v_add_f32 v104, v104, v120
    v_add_f32 v106, v106, v122
    v_add_f32 v104, v104, v124
    v_add_f32 v106, v106, v126
    v_add_f32 v104, v104, v128
    v_add_f32 v106, v106, v130
    v_add_f32 v104, v104, v132
    v_add_f32 v106, v106, v134
    v_mov_b32 v105, v104
    v_mov_b32 v107, v106
    s_mov_b32 s56, 0x3b000000
    s_nop 0
    v_permlane32_swap_b32 v104, v105
    v_permlane32_swap_b32 v106, v107
    s_nop 1
    v_add_f32 v10, v104, v105
    v_add_f32 v11, v106, v107

    s_mov_b32 s56, 0x3b000000
    v_mul_f32 v10, s56, v10
    v_mul_f32 v11, s56, v11
    v_fma_f32 v11, -v10, v10, v11
    v_max_f32 v11, 0, v11
    v_cvt_pk_bf16_f32 v13, v10, v11
    v_lshlrev_b32 v10, 16, v13
    v_and_b32 v11, 0xffff0000, v13
    v_add_f32 v11, 0x3727c5ac, v11
    v_cvt_pk_bf16_f32 v13, v11, v11
    v_and_b32 v11, 0xffff0000, v13
    v_sqrt_f32 v11, v11
    s_nop 0
    v_cvt_pk_bf16_f32 v13, v11, v11
    v_and_b32 v11, 0xffff0000, v13
    v_rcp_f32 v12, v11
    s_nop 0
    v_mul_f32 v14, v10, v12
    v_sub_f32 v14, 0, v14

    v_mov_b32 v13, v12
    v_mov_b32 v15, v14

    v_pk_fma_f32 v[48:49], v[32:33], v[12:13], v[14:15]
    v_pk_fma_f32 v[50:51], v[34:35], v[12:13], v[14:15]
    v_pk_fma_f32 v[52:53], v[36:37], v[12:13], v[14:15]
    v_pk_fma_f32 v[54:55], v[38:39], v[12:13], v[14:15]
    v_pk_fma_f32 v[56:57], v[40:41], v[12:13], v[14:15]
    v_pk_fma_f32 v[58:59], v[42:43], v[12:13], v[14:15]
    v_pk_fma_f32 v[60:61], v[44:45], v[12:13], v[14:15]
    v_pk_fma_f32 v[62:63], v[46:47], v[12:13], v[14:15]
    v_pk_fma_f32 v[48:49], v[48:49], v[88:89], v[32:33]
    v_pk_fma_f32 v[50:51], v[50:51], v[90:91], v[34:35]
    v_pk_fma_f32 v[52:53], v[52:53], v[92:93], v[36:37]
    v_pk_fma_f32 v[54:55], v[54:55], v[94:95], v[38:39]
    v_pk_fma_f32 v[56:57], v[56:57], v[96:97], v[40:41]
    v_pk_fma_f32 v[58:59], v[58:59], v[98:99], v[42:43]
    v_pk_fma_f32 v[60:61], v[60:61], v[100:101], v[44:45]
    v_pk_fma_f32 v[62:63], v[62:63], v[102:103], v[46:47]
    v_cvt_pk_bf16_f32 v80, v48, v49
    v_cvt_pk_bf16_f32 v81, v50, v51
    v_cvt_pk_bf16_f32 v82, v52, v53
    v_cvt_pk_bf16_f32 v83, v54, v55
    v_cvt_pk_bf16_f32 v84, v56, v57
    v_cvt_pk_bf16_f32 v85, v58, v59
    v_cvt_pk_bf16_f32 v86, v60, v61
    v_cvt_pk_bf16_f32 v87, v62, v63
    s_cmp_eq_u32 s3, 0
    s_cbranch_scc1 mega_ops0
    buffer_store_dwordx4 v[80:83], v7, s[20:23], s58 offen
    buffer_store_dwordx4 v[84:87], v7, s[20:23], s58 offen offset:32

    s_endpgm
mega_ops0:
    v_min_u32 v80, s67, v80
    v_min_u32 v81, s67, v81
    v_min_u32 v82, s67, v82
    v_min_u32 v83, s67, v83
    v_min_u32 v84, s67, v84
    v_min_u32 v85, s67, v85
    v_min_u32 v86, s67, v86
    v_min_u32 v87, s67, v87
    buffer_store_dwordx4 v[80:83], v3, s[24:27], s55 offen
    buffer_store_dwordx4 v[84:87], v3, s[24:27], s55 offen offset:1024
    s_add_u32 s55, s55, 0x1000000
    v_mov_b32 v10, 0
    v_mov_b32 v11, 0

    v_dot2c_f32_bf16 v10, s62, v80
    v_dot2c_f32_bf16 v11, v80, v80
    v_dot2c_f32_bf16 v10, s62, v81
    v_dot2c_f32_bf16 v11, v81, v81
    v_dot2c_f32_bf16 v10, s62, v82
    v_dot2c_f32_bf16 v11, v82, v82
    v_dot2c_f32_bf16 v10, s62, v83
    v_dot2c_f32_bf16 v11, v83, v83
    v_dot2c_f32_bf16 v10, s62, v84
    v_dot2c_f32_bf16 v11, v84, v84
    v_dot2c_f32_bf16 v10, s62, v85
    v_dot2c_f32_bf16 v11, v85, v85
    v_dot2c_f32_bf16 v10, s62, v86
    v_dot2c_f32_bf16 v11, v86, v86
    v_dot2c_f32_bf16 v10, s62, v87
    v_dot2c_f32_bf16 v11, v87, v87
    v_lshrrev_b32 v8, 1, v8
    s_sub_u32 s60, s60, 0x1400000
    s_lshr_b32 s61, s60, 1
    s_add_u32 s61, s61, 0x1510000
    v_mov_b32 v12, v10
    v_mov_b32 v13, v11
    s_lshr_b32 s60, s60, 7
    s_add_u32 s60, s60, 0x1565000
    v_permlane32_swap_b32 v10, v12
    v_permlane32_swap_b32 v11, v13
    s_nop 0
    v_add_f32 v10, v10, v12
    v_add_f32 v11, v11, v13
    v_min_u32 v10, s67, v10
    v_min_u32 v11, s67, v11
    s_mov_b64 exec, 0xffffffff
    buffer_store_dwordx2 v[10:11], v8, s[24:27], s61 offen
    s_add_u32 s61, s61, 0x1000000
    buffer_store_dwordx2 v[10:11], v8, s[24:27], s61 offen sc1
    s_mov_b64 exec, -1
    buffer_store_dwordx4 v[80:83], v3, s[24:27], s55 offen sc1
    buffer_store_dwordx4 v[84:87], v3, s[24:27], s55 offen offset:1024 sc1

mega_qkv:
    s_lshl_b32 s41, s36, 1
    s_and_b32 s46, s37, 1
    s_add_u32 s41, s41, s46
    s_lshr_b32 s42, s37, 1
    s_and_b32 s39, s40, 3
    s_lshl_b32 s43, s41, 2
    s_add_u32 s43, s43, s39
    s_cmp_lt_u32 s40, 4
    s_cbranch_scc1 mega_qc
    s_cmp_lt_u32 s40, 8
    s_cbranch_scc1 mega_qb
    s_lshl_b32 s53, s39, 10
    s_mul_i32 s52, s42, 98304
    s_add_u32 s52, s52, s53
    s_add_u32 s52, s52, 0x1600000

    s_add_u32 m0, s53, 0
    s_add_u32 s51, s52, 0
    buffer_load_dwordx4 v3, s[24:27], s51 offen sc1 lds
    s_add_u32 m0, s53, 4096
    s_add_u32 s51, s52, 4096
    buffer_load_dwordx4 v3, s[24:27], s51 offen sc1 lds
    s_add_u32 m0, s53, 8192
    s_add_u32 s51, s52, 8192
    buffer_load_dwordx4 v3, s[24:27], s51 offen sc1 lds
    s_add_u32 m0, s53, 12288
    s_add_u32 s51, s52, 12288
    buffer_load_dwordx4 v3, s[24:27], s51 offen sc1 lds
    s_add_u32 m0, s53, 16384
    s_add_u32 s51, s52, 16384
    buffer_load_dwordx4 v3, s[24:27], s51 offen sc1 lds
    s_add_u32 m0, s53, 20480
    s_add_u32 s51, s52, 20480
    buffer_load_dwordx4 v3, s[24:27], s51 offen sc1 lds
    s_add_u32 m0, s53, 24576
    s_add_u32 s51, s52, 24576
    buffer_load_dwordx4 v3, s[24:27], s51 offen sc1 lds
    s_add_u32 m0, s53, 28672
    s_add_u32 s51, s52, 28672
    buffer_load_dwordx4 v3, s[24:27], s51 offen sc1 lds
    s_waitcnt vmcnt(7)
    s_add_u32 m0, s53, 32768
    s_add_u32 s51, s52, 32768
    buffer_load_dwordx4 v3, s[24:27], s51 offen sc1 lds
    s_waitcnt vmcnt(7)
    s_add_u32 m0, s53, 36864
    s_add_u32 s51, s52, 36864
    buffer_load_dwordx4 v3, s[24:27], s51 offen sc1 lds
    s_waitcnt vmcnt(7)
    s_add_u32 m0, s53, 40960
    s_add_u32 s51, s52, 40960
    buffer_load_dwordx4 v3, s[24:27], s51 offen sc1 lds
    s_waitcnt vmcnt(7)
    s_add_u32 m0, s53, 45056
    s_add_u32 s51, s52, 45056
    buffer_load_dwordx4 v3, s[24:27], s51 offen sc1 lds
    s_waitcnt vmcnt(7)
    s_add_u32 m0, s53, 49152
    s_add_u32 s51, s52, 49152
    buffer_load_dwordx4 v3, s[24:27], s51 offen sc1 lds
    s_waitcnt vmcnt(7)
    s_add_u32 m0, s53, 53248
    s_add_u32 s51, s52, 53248
    buffer_load_dwordx4 v3, s[24:27], s51 offen sc1 lds
    s_waitcnt vmcnt(7)
    s_add_u32 m0, s53, 57344
    s_add_u32 s51, s52, 57344
    buffer_load_dwordx4 v3, s[24:27], s51 offen sc1 lds
    s_waitcnt vmcnt(7)
    s_add_u32 m0, s53, 61440
    s_add_u32 s51, s52, 61440
    buffer_load_dwordx4 v3, s[24:27], s51 offen sc1 lds
    s_waitcnt vmcnt(7)
    s_add_u32 m0, s53, 65536
    s_add_u32 s51, s52, 65536
    buffer_load_dwordx4 v3, s[24:27], s51 offen sc1 lds
    s_waitcnt vmcnt(7)
    s_add_u32 m0, s53, 69632
    s_add_u32 s51, s52, 69632
    buffer_load_dwordx4 v3, s[24:27], s51 offen sc1 lds
    s_waitcnt vmcnt(7)
    s_add_u32 m0, s53, 73728
    s_add_u32 s51, s52, 73728
    buffer_load_dwordx4 v3, s[24:27], s51 offen sc1 lds
    s_waitcnt vmcnt(7)
    s_add_u32 m0, s53, 77824
    s_add_u32 s51, s52, 77824
    buffer_load_dwordx4 v3, s[24:27], s51 offen sc1 lds
    s_waitcnt vmcnt(7)
    s_add_u32 m0, s53, 81920
    s_add_u32 s51, s52, 81920
    buffer_load_dwordx4 v3, s[24:27], s51 offen sc1 lds
    s_waitcnt vmcnt(7)
    s_add_u32 m0, s53, 86016
    s_add_u32 s51, s52, 86016
    buffer_load_dwordx4 v3, s[24:27], s51 offen sc1 lds
    s_waitcnt vmcnt(7)
    s_add_u32 m0, s53, 90112
    s_add_u32 s51, s52, 90112
    buffer_load_dwordx4 v3, s[24:27], s51 offen sc1 lds
    s_waitcnt vmcnt(7)
    s_add_u32 m0, s53, 94208
    s_add_u32 s51, s52, 94208
    buffer_load_dwordx4 v3, s[24:27], s51 offen sc1 lds
    s_waitcnt vmcnt(7)
    s_waitcnt vmcnt(0)
    s_barrier
    s_branch mega_qw

mega_qb:
    v_lshlrev_b32 v7, 3, v1
    s_lshl_b32 s52, s43, 12
    s_add_u32 s52, s52, 0x1510000
    s_min_u32 s53, s39, 2
    s_lshl_b32 s51, s53, 11
    s_lshl_b32 s54, s42, 7
    s_add_u32 s51, s51, s54
    s_add_u32 s51, s51, 0x1500000
    v_and_b32 v4, 31, v1
    v_lshlrev_b32 v4, 2, v4
    buffer_load_dword v32, v4, s[24:27], s51 offen sc1
    s_lshl_b32 s53, s53, 7
    s_add_u32 s53, s53, 100352
    v_add_u32 v5, s53, v4
    s_lshl_b32 s53, s39, 9
    s_add_u32 s53, s53, 98304
    v_add_u32 v4, s53, v4

    s_mov_b32 s69, 0x8000
mega_stp:
    buffer_load_dwordx2 v[16:17], v7, s[24:27], s52 offen offset:0 sc1
    buffer_load_dwordx2 v[18:19], v7, s[24:27], s52 offen offset:512 sc1
    buffer_load_dwordx2 v[20:21], v7, s[24:27], s52 offen offset:1024 sc1
    buffer_load_dwordx2 v[22:23], v7, s[24:27], s52 offen offset:1536 sc1
    buffer_load_dwordx2 v[24:25], v7, s[24:27], s52 offen offset:2048 sc1
    buffer_load_dwordx2 v[26:27], v7, s[24:27], s52 offen offset:2560 sc1
    buffer_load_dwordx2 v[28:29], v7, s[24:27], s52 offen offset:3072 sc1
    buffer_load_dwordx2 v[30:31], v7, s[24:27], s52 offen offset:3584 sc1
    s_waitcnt vmcnt(0)
    v_max3_u32 v15, v16, v17, v18
    v_max3_u32 v15, v15, v19, v20
    v_max3_u32 v15, v15, v21, v22
    v_max3_u32 v15, v15, v23, v24
    v_max3_u32 v15, v15, v25, v26
    v_max3_u32 v15, v15, v27, v28
    v_max3_u32 v15, v15, v29, v30
    v_max_u32 v15, v15, v31
    v_cmp_eq_u32 vcc, -1, v15
    s_cmp_eq_u64 vcc, 0
    s_cbranch_scc1 mega_std
    s_sub_u32 s69, s69, 1
    s_cbranch_scc1 mega_std

    s_cmp_lg_u32 s69, 32744
    s_cbranch_scc1 mega_stp_ns

    v_or_b32 v7, 0x1000000, v7
mega_stp_ns:
    s_sleep 1
    s_branch mega_stp

mega_std:
    s_lshl_b32 s58, s39, 2
    s_add_u32 s58, s58, 160032
    v_mov_b32 v6, s58
    v_or_b32 v8, 1, v7
    s_mov_b64 exec, 1
    ds_write_b32 v6, v8
    s_mov_b64 exec, -1

    v_add_f32 v16, v16, v18
    v_add_f32 v17, v17, v19
    v_add_f32 v16, v16, v20
    v_add_f32 v17, v17, v21
    v_add_f32 v16, v16, v22
    v_add_f32 v17, v17, v23
    v_add_f32 v16, v16, v24
    v_add_f32 v17, v17, v25
    v_add_f32 v16, v16, v26
    v_add_f32 v17, v17, v27
    v_add_f32 v16, v16, v28
    v_add_f32 v17, v17, v29
    v_add_f32 v16, v16, v30
    v_add_f32 v17, v17, v31
    v_mov_b32 v18, v16
    v_mov_b32 v19, v17
    s_mov_b32 s56, 0x3b000000
    s_nop 0
    v_permlane32_swap_b32 v16, v18
    v_permlane32_swap_b32 v17, v19
    s_nop 0
    v_add_f32 v16, v16, v18
    v_add_f32 v17, v17, v19

    s_mov_b32 s56, 0x3b000000
    v_mul_f32 v16, s56, v16
    v_mul_f32 v17, s56, v17
    v_fma_f32 v17, -v16, v16, v17
    v_max_f32 v17, 0, v17
    v_cvt_pk_bf16_f32 v18, v16, v17
    v_lshlrev_b32 v16, 16, v18
    v_and_b32 v17, 0xffff0000, v18
    v_add_f32 v17, 0x3727c5ac, v17
    v_cvt_pk_bf16_f32 v18, v17, v17
    v_and_b32 v17, 0xffff0000, v18
    v_sqrt_f32 v17, v17
    s_nop 0
    v_cvt_pk_bf16_f32 v18, v17, v17
    v_and_b32 v17, 0xffff0000, v18
    v_rcp_f32 v17, v17
    s_nop 0
    v_mul_f32 v16, v16, v17
    v_sub_f32 v16, 0, v16

    ds_write_b32 v4, v17
    ds_write_b32 v4, v16 offset:128
    ds_write_b32 v5, v32
    s_waitcnt lgkmcnt(0)
    s_barrier

mega_qw:
    s_barrier
mega_qw2:
    s_barrier
    s_branch mega_qend

mega_qc:
    s_lshl_b32 s49, s43, 15
    s_add_u32 s49, s49, 0x1000000

    s_add_u32 s58, s49, 0
    s_add_u32 s59, s49, 4096
    s_add_u32 s60, s49, 8192
    s_add_u32 s61, s49, 12288
    s_add_u32 s62, s49, 16384
    s_add_u32 s63, s49, 20480
    s_add_u32 s52, s49, 24576
    s_add_u32 s53, s49, 28672
    s_lshl_b32 s50, s40, 2
    s_add_u32 s50, s50, 160032
    v_mov_b32 v14, s50

mega_xw:
    ds_read_b32 v16, v14
    s_waitcnt lgkmcnt(0)
    v_readfirstlane_b32 s50, v16
    s_cmp_lg_u32 s50, 0
    s_cbranch_scc0 mega_xw
    s_and_b32 s50, s50, 0x1000000
    v_or_b32 v16, s50, v3

    buffer_load_dwordx4 v[20:23], v16, s[24:27], s58 offen offset:0 sc1
    buffer_load_dwordx4 v[24:27], v16, s[24:27], s58 offen offset:1024 sc1
    buffer_load_dwordx4 v[28:31], v16, s[24:27], s58 offen offset:2048 sc1
    buffer_load_dwordx4 v[32:35], v16, s[24:27], s58 offen offset:3072 sc1
    buffer_load_dwordx4 v[36:39], v16, s[24:27], s59 offen offset:0 sc1
    buffer_load_dwordx4 v[40:43], v16, s[24:27], s59 offen offset:1024 sc1
    buffer_load_dwordx4 v[44:47], v16, s[24:27], s59 offen offset:2048 sc1
    buffer_load_dwordx4 v[48:51], v16, s[24:27], s59 offen offset:3072 sc1
    buffer_load_dwordx4 v[52:55], v16, s[24:27], s60 offen offset:0 sc1
    buffer_load_dwordx4 v[56:59], v16, s[24:27], s60 offen offset:1024 sc1
    buffer_load_dwordx4 v[60:63], v16, s[24:27], s60 offen offset:2048 sc1
    buffer_load_dwordx4 v[64:67], v16, s[24:27], s60 offen offset:3072 sc1
    buffer_load_dwordx4 v[68:71], v16, s[24:27], s61 offen offset:0 sc1
    buffer_load_dwordx4 v[72:75], v16, s[24:27], s61 offen offset:1024 sc1
    buffer_load_dwordx4 v[76:79], v16, s[24:27], s61 offen offset:2048 sc1
    buffer_load_dwordx4 v[80:83], v16, s[24:27], s61 offen offset:3072 sc1
    v_lshrrev_b32 v6, 5, v1
    v_and_b32 v4, 31, v1
    v_lshlrev_b32 v18, 9, v6
    v_bfe_u32 v19, v1, 2, 2
    v_lshl_add_u32 v18, v19, 6, v18
    v_bfe_u32 v19, v1, 4, 1
    v_lshl_add_u32 v18, v19, 5, v18
    v_and_b32 v19, 3, v1
    v_lshl_add_u32 v18, v19, 3, v18
    v_add_u32 v19, 49152, v18
    s_lshl_b32 s50, s40, 9
    s_add_u32 s50, s50, 98304
    v_lshl_add_u32 v12, v4, 2, s50
    v_lshl_add_u32 v11, v6, 4, s50
    v_lshlrev_b32 v13, 4, v6
    v_add_u32 v13, 98304, v13
    v_lshlrev_b32 v5, 2, v4
    v_add_u32 v5, 98304, v5
    s_lshl_b32 s57, s42, 17
    s_lshl_b32 s51, s43, 10
    s_add_u32 s57, s57, s51
    s_add_u32 s57, s57, 0x600000
    v_and_b32 v10, 3, v1
    v_bfe_u32 v9, v1, 2, 1
    v_lshl_or_b32 v10, v9, 3, v10
    v_bfe_u32 v9, v1, 3, 1
    v_lshl_or_b32 v10, v9, 2, v10
    v_lshlrev_b32 v10, 4, v10
    v_lshl_or_b32 v10, v6, 8, v10
    v_bfe_u32 v9, v1, 4, 1
    v_lshl_or_b32 v10, v9, 16, v10
    s_barrier

    ds_read_b64_tr_b16 v[132:133], v18 offset:0
    ds_read_b64_tr_b16 v[134:135], v18 offset:256
    ds_read_b64_tr_b16 v[136:137], v18 offset:4096
    ds_read_b64_tr_b16 v[138:139], v18 offset:4352
    ds_read_b64_tr_b16 v[140:141], v18 offset:8192
    ds_read_b64_tr_b16 v[142:143], v18 offset:8448
    ds_read_b64_tr_b16 v[144:145], v18 offset:1024
    ds_read_b64_tr_b16 v[146:147], v18 offset:1280
    ds_read_b64_tr_b16 v[148:149], v18 offset:5120
    ds_read_b64_tr_b16 v[150:151], v18 offset:5376
    ds_read_b64_tr_b16 v[152:153], v18 offset:9216
    ds_read_b64_tr_b16 v[154:155], v18 offset:9472
    s_mov_b32 s69, 0x8000
    s_waitcnt vmcnt(12)
    s_branch mega_ck_49_c
mega_ck_49:
    buffer_load_dwordx4 v[20:23], v16, s[24:27], s58 offen offset:0 sc1
    buffer_load_dwordx4 v[24:27], v16, s[24:27], s58 offen offset:1024 sc1
    buffer_load_dwordx4 v[28:31], v16, s[24:27], s58 offen offset:2048 sc1
    buffer_load_dwordx4 v[32:35], v16, s[24:27], s58 offen offset:3072 sc1
    s_waitcnt vmcnt(0)
mega_ck_49_c:
    v_max3_u32 v15, v20, v21, v22
    v_max3_u32 v15, v15, v23, v24
    v_max3_u32 v15, v15, v25, v26
    v_max3_u32 v15, v15, v27, v28
    v_max3_u32 v15, v15, v29, v30
    v_max3_u32 v15, v15, v31, v32
    v_max3_u32 v15, v15, v33, v34
    v_max_u32 v15, v15, v35
    v_cmp_eq_u32 vcc, -1, v15
    s_cmp_eq_u64 vcc, 0
    s_cbranch_scc1 mega_ck_49_d
    s_sub_u32 s69, s69, 1
    s_cbranch_scc1 mega_ck_49_d

    s_cmp_lg_u32 s69, 32744
    s_cbranch_scc1 mega_ck_49_ns

    v_or_b32 v16, 0x1000000, v16
mega_ck_49_ns:
    s_sleep 1
    s_branch mega_ck_49

mega_ck_49_d:
    s_waitcnt lgkmcnt(6)
    v_mfma_f32_32x32x16_bf16 v[84:99], v[132:135], v[20:23], 0
    ds_read_b64_tr_b16 v[156:157], v18 offset:2048
    ds_read_b64_tr_b16 v[158:159], v18 offset:2304
    v_mfma_f32_32x32x16_bf16 v[100:115], v[136:139], v[20:23], 0
    ds_read_b64_tr_b16 v[160:161], v18 offset:6144
    ds_read_b64_tr_b16 v[162:163], v18 offset:6400
    v_mfma_f32_32x32x16_bf16 v[116:131], v[20:23], v[140:143], 0
    ds_read_b64_tr_b16 v[164:165], v18 offset:10240
    ds_read_b64_tr_b16 v[166:167], v18 offset:10496
    buffer_load_dwordx4 v[20:23], v16, s[24:27], s62 offen offset:0 sc1
    s_waitcnt lgkmcnt(6)
    v_mfma_f32_32x32x16_bf16 v[84:99], v[144:147], v[24:27], v[84:99]
    ds_read_b64_tr_b16 v[132:133], v18 offset:3072
    ds_read_b64_tr_b16 v[134:135], v18 offset:3328
    v_mfma_f32_32x32x16_bf16 v[100:115], v[148:151], v[24:27], v[100:115]
    ds_read_b64_tr_b16 v[136:137], v18 offset:7168
    ds_read_b64_tr_b16 v[138:139], v18 offset:7424
    v_mfma_f32_32x32x16_bf16 v[116:131], v[24:27], v[152:155], v[116:131]
    ds_read_b64_tr_b16 v[140:141], v18 offset:11264
    ds_read_b64_tr_b16 v[142:143], v18 offset:11520
    buffer_load_dwordx4 v[24:27], v16, s[24:27], s62 offen offset:1024 sc1
    s_waitcnt lgkmcnt(6)
    v_mfma_f32_32x32x16_bf16 v[84:99], v[156:159], v[28:31], v[84:99]
    ds_read_b64_tr_b16 v[144:145], v18 offset:12288
    ds_read_b64_tr_b16 v[146:147], v18 offset:12544
    v_mfma_f32_32x32x16_bf16 v[100:115], v[160:163], v[28:31], v[100:115]
    ds_read_b64_tr_b16 v[148:149], v18 offset:16384
    ds_read_b64_tr_b16 v[150:151], v18 offset:16640
    v_mfma_f32_32x32x16_bf16 v[116:131], v[28:31], v[164:167], v[116:131]
    ds_read_b64_tr_b16 v[152:153], v18 offset:20480
    ds_read_b64_tr_b16 v[154:155], v18 offset:20736
    buffer_load_dwordx4 v[28:31], v16, s[24:27], s62 offen offset:2048 sc1
    s_waitcnt lgkmcnt(6)
    v_mfma_f32_32x32x16_bf16 v[84:99], v[132:135], v[32:35], v[84:99]
    ds_read_b64_tr_b16 v[156:157], v18 offset:13312
    ds_read_b64_tr_b16 v[158:159], v18 offset:13568
    v_mfma_f32_32x32x16_bf16 v[100:115], v[136:139], v[32:35], v[100:115]
    ds_read_b64_tr_b16 v[160:161], v18 offset:17408
    ds_read_b64_tr_b16 v[162:163], v18 offset:17664
    v_mfma_f32_32x32x16_bf16 v[116:131], v[32:35], v[140:143], v[116:131]
    ds_read_b64_tr_b16 v[164:165], v18 offset:21504
    ds_read_b64_tr_b16 v[166:167], v18 offset:21760
    s_mov_b32 s69, 0x8000
    s_waitcnt vmcnt(11)
    s_branch mega_ck_50_c
mega_ck_50:
    buffer_load_dwordx4 v[36:39], v16, s[24:27], s59 offen offset:0 sc1
    buffer_load_dwordx4 v[40:43], v16, s[24:27], s59 offen offset:1024 sc1
    buffer_load_dwordx4 v[44:47], v16, s[24:27], s59 offen offset:2048 sc1
    buffer_load_dwordx4 v[48:51], v16, s[24:27], s59 offen offset:3072 sc1
    s_waitcnt vmcnt(0)
mega_ck_50_c:
    v_max3_u32 v15, v36, v37, v38
    v_max3_u32 v15, v15, v39, v40
    v_max3_u32 v15, v15, v41, v42
    v_max3_u32 v15, v15, v43, v44
    v_max3_u32 v15, v15, v45, v46
    v_max3_u32 v15, v15, v47, v48
    v_max3_u32 v15, v15, v49, v50
    v_max_u32 v15, v15, v51
    v_cmp_eq_u32 vcc, -1, v15
    s_cmp_eq_u64 vcc, 0
    s_cbranch_scc1 mega_ck_50_d
    s_sub_u32 s69, s69, 1
    s_cbranch_scc1 mega_ck_50_d

    s_cmp_lg_u32 s69, 32744
    s_cbranch_scc1 mega_ck_50_ns

    v_or_b32 v16, 0x1000000, v16
mega_ck_50_ns:
    s_sleep 1
    s_branch mega_ck_50

mega_ck_50_d:
    buffer_load_dwordx4 v[32:35], v16, s[24:27], s62 offen offset:3072 sc1
    s_waitcnt lgkmcnt(6)
    v_mfma_f32_32x32x16_bf16 v[84:99], v[144:147], v[36:39], v[84:99]
    ds_read_b64_tr_b16 v[132:133], v18 offset:14336
    ds_read_b64_tr_b16 v[134:135], v18 offset:14592
    v_mfma_f32_32x32x16_bf16 v[100:115], v[148:151], v[36:39], v[100:115]
    ds_read_b64_tr_b16 v[136:137], v18 offset:18432
    ds_read_b64_tr_b16 v[138:139], v18 offset:18688
    v_mfma_f32_32x32x16_bf16 v[116:131], v[36:39], v[152:155], v[116:131]
    ds_read_b64_tr_b16 v[140:141], v18 offset:22528
    ds_read_b64_tr_b16 v[142:143], v18 offset:22784
    buffer_load_dwordx4 v[36:39], v16, s[24:27], s63 offen offset:0 sc1
    s_waitcnt lgkmcnt(6)
    v_mfma_f32_32x32x16_bf16 v[84:99], v[156:159], v[40:43], v[84:99]
    ds_read_b64_tr_b16 v[144:145], v18 offset:15360
    ds_read_b64_tr_b16 v[146:147], v18 offset:15616
    v_mfma_f32_32x32x16_bf16 v[100:115], v[160:163], v[40:43], v[100:115]
    ds_read_b64_tr_b16 v[148:149], v18 offset:19456
    ds_read_b64_tr_b16 v[150:151], v18 offset:19712
    v_mfma_f32_32x32x16_bf16 v[116:131], v[40:43], v[164:167], v[116:131]
    ds_read_b64_tr_b16 v[152:153], v18 offset:23552
    ds_read_b64_tr_b16 v[154:155], v18 offset:23808
    buffer_load_dwordx4 v[40:43], v16, s[24:27], s63 offen offset:1024 sc1
    s_waitcnt lgkmcnt(6)
    v_mfma_f32_32x32x16_bf16 v[84:99], v[132:135], v[44:47], v[84:99]
    ds_read_b64_tr_b16 v[156:157], v18 offset:24576
    ds_read_b64_tr_b16 v[158:159], v18 offset:24832
    v_mfma_f32_32x32x16_bf16 v[100:115], v[136:139], v[44:47], v[100:115]
    ds_read_b64_tr_b16 v[160:161], v18 offset:28672
    ds_read_b64_tr_b16 v[162:163], v18 offset:28928
    v_mfma_f32_32x32x16_bf16 v[116:131], v[44:47], v[140:143], v[116:131]
    ds_read_b64_tr_b16 v[164:165], v18 offset:32768
    ds_read_b64_tr_b16 v[166:167], v18 offset:33024
    buffer_load_dwordx4 v[44:47], v16, s[24:27], s63 offen offset:2048 sc1
    s_waitcnt lgkmcnt(6)
    v_mfma_f32_32x32x16_bf16 v[84:99], v[144:147], v[48:51], v[84:99]
    ds_read_b64_tr_b16 v[132:133], v18 offset:25600
    ds_read_b64_tr_b16 v[134:135], v18 offset:25856
    v_mfma_f32_32x32x16_bf16 v[100:115], v[148:151], v[48:51], v[100:115]
    ds_read_b64_tr_b16 v[136:137], v18 offset:29696
    ds_read_b64_tr_b16 v[138:139], v18 offset:29952
    v_mfma_f32_32x32x16_bf16 v[116:131], v[48:51], v[152:155], v[116:131]
    ds_read_b64_tr_b16 v[140:141], v18 offset:33792
    ds_read_b64_tr_b16 v[142:143], v18 offset:34048
    s_mov_b32 s69, 0x8000
    s_waitcnt vmcnt(11)
    s_branch mega_ck_51_c
mega_ck_51:
    buffer_load_dwordx4 v[52:55], v16, s[24:27], s60 offen offset:0 sc1
    buffer_load_dwordx4 v[56:59], v16, s[24:27], s60 offen offset:1024 sc1
    buffer_load_dwordx4 v[60:63], v16, s[24:27], s60 offen offset:2048 sc1
    buffer_load_dwordx4 v[64:67], v16, s[24:27], s60 offen offset:3072 sc1
    s_waitcnt vmcnt(0)
mega_ck_51_c:
    v_max3_u32 v15, v52, v53, v54
    v_max3_u32 v15, v15, v55, v56
    v_max3_u32 v15, v15, v57, v58
    v_max3_u32 v15, v15, v59, v60
    v_max3_u32 v15, v15, v61, v62
    v_max3_u32 v15, v15, v63, v64
    v_max3_u32 v15, v15, v65, v66
    v_max_u32 v15, v15, v67
    v_cmp_eq_u32 vcc, -1, v15
    s_cmp_eq_u64 vcc, 0
    s_cbranch_scc1 mega_ck_51_d
    s_sub_u32 s69, s69, 1
    s_cbranch_scc1 mega_ck_51_d

    s_cmp_lg_u32 s69, 32744
    s_cbranch_scc1 mega_ck_51_ns

    v_or_b32 v16, 0x1000000, v16
mega_ck_51_ns:
    s_sleep 1
    s_branch mega_ck_51

mega_ck_51_d:
    buffer_load_dwordx4 v[48:51], v16, s[24:27], s63 offen offset:3072 sc1
    s_waitcnt lgkmcnt(6)
    v_mfma_f32_32x32x16_bf16 v[84:99], v[156:159], v[52:55], v[84:99]
    ds_read_b64_tr_b16 v[144:145], v18 offset:26624
    ds_read_b64_tr_b16 v[146:147], v18 offset:26880
    v_mfma_f32_32x32x16_bf16 v[100:115], v[160:163], v[52:55], v[100:115]
    ds_read_b64_tr_b16 v[148:149], v18 offset:30720
    ds_read_b64_tr_b16 v[150:151], v18 offset:30976
    v_mfma_f32_32x32x16_bf16 v[116:131], v[52:55], v[164:167], v[116:131]
    ds_read_b64_tr_b16 v[152:153], v18 offset:34816
    ds_read_b64_tr_b16 v[154:155], v18 offset:35072
    buffer_load_dwordx4 v[52:55], v16, s[24:27], s52 offen offset:0 sc1
    s_waitcnt lgkmcnt(6)
    v_mfma_f32_32x32x16_bf16 v[84:99], v[132:135], v[56:59], v[84:99]
    ds_read_b64_tr_b16 v[156:157], v18 offset:27648
    ds_read_b64_tr_b16 v[158:159], v18 offset:27904
    v_mfma_f32_32x32x16_bf16 v[100:115], v[136:139], v[56:59], v[100:115]
    ds_read_b64_tr_b16 v[160:161], v18 offset:31744
    ds_read_b64_tr_b16 v[162:163], v18 offset:32000
    v_mfma_f32_32x32x16_bf16 v[116:131], v[56:59], v[140:143], v[116:131]
    ds_read_b64_tr_b16 v[164:165], v18 offset:35840
    ds_read_b64_tr_b16 v[166:167], v18 offset:36096
    buffer_load_dwordx4 v[56:59], v16, s[24:27], s52 offen offset:1024 sc1
    s_waitcnt lgkmcnt(6)
    v_mfma_f32_32x32x16_bf16 v[84:99], v[144:147], v[60:63], v[84:99]
    ds_read_b64_tr_b16 v[132:133], v18 offset:36864
    ds_read_b64_tr_b16 v[134:135], v18 offset:37120
    v_mfma_f32_32x32x16_bf16 v[100:115], v[148:151], v[60:63], v[100:115]
    ds_read_b64_tr_b16 v[136:137], v18 offset:40960
    ds_read_b64_tr_b16 v[138:139], v18 offset:41216
    v_mfma_f32_32x32x16_bf16 v[116:131], v[60:63], v[152:155], v[116:131]
    ds_read_b64_tr_b16 v[140:141], v18 offset:45056
    ds_read_b64_tr_b16 v[142:143], v18 offset:45312
    buffer_load_dwordx4 v[60:63], v16, s[24:27], s52 offen offset:2048 sc1
    s_waitcnt lgkmcnt(6)
    v_mfma_f32_32x32x16_bf16 v[84:99], v[156:159], v[64:67], v[84:99]
    ds_read_b64_tr_b16 v[144:145], v18 offset:37888
    ds_read_b64_tr_b16 v[146:147], v18 offset:38144
    v_mfma_f32_32x32x16_bf16 v[100:115], v[160:163], v[64:67], v[100:115]
    ds_read_b64_tr_b16 v[148:149], v18 offset:41984
    ds_read_b64_tr_b16 v[150:151], v18 offset:42240
    v_mfma_f32_32x32x16_bf16 v[116:131], v[64:67], v[164:167], v[116:131]
    ds_read_b64_tr_b16 v[152:153], v18 offset:46080
    ds_read_b64_tr_b16 v[154:155], v18 offset:46336
    s_mov_b32 s69, 0x8000
    s_waitcnt vmcnt(11)
    s_branch mega_ck_52_c
mega_ck_52:
    buffer_load_dwordx4 v[68:71], v16, s[24:27], s61 offen offset:0 sc1
    buffer_load_dwordx4 v[72:75], v16, s[24:27], s61 offen offset:1024 sc1
    buffer_load_dwordx4 v[76:79], v16, s[24:27], s61 offen offset:2048 sc1
    buffer_load_dwordx4 v[80:83], v16, s[24:27], s61 offen offset:3072 sc1
    s_waitcnt vmcnt(0)
mega_ck_52_c:
    v_max3_u32 v15, v68, v69, v70
    v_max3_u32 v15, v15, v71, v72
    v_max3_u32 v15, v15, v73, v74
    v_max3_u32 v15, v15, v75, v76
    v_max3_u32 v15, v15, v77, v78
    v_max3_u32 v15, v15, v79, v80
    v_max3_u32 v15, v15, v81, v82
    v_max_u32 v15, v15, v83
    v_cmp_eq_u32 vcc, -1, v15
    s_cmp_eq_u64 vcc, 0
    s_cbranch_scc1 mega_ck_52_d
    s_sub_u32 s69, s69, 1
    s_cbranch_scc1 mega_ck_52_d

    s_cmp_lg_u32 s69, 32744
    s_cbranch_scc1 mega_ck_52_ns

    v_or_b32 v16, 0x1000000, v16
mega_ck_52_ns:
    s_sleep 1
    s_branch mega_ck_52

mega_ck_52_d:
    buffer_load_dwordx4 v[64:67], v16, s[24:27], s52 offen offset:3072 sc1
    s_waitcnt lgkmcnt(6)
    v_mfma_f32_32x32x16_bf16 v[84:99], v[132:135], v[68:71], v[84:99]
    ds_read_b64_tr_b16 v[156:157], v18 offset:38912
    ds_read_b64_tr_b16 v[158:159], v18 offset:39168
    v_mfma_f32_32x32x16_bf16 v[100:115], v[136:139], v[68:71], v[100:115]
    ds_read_b64_tr_b16 v[160:161], v18 offset:43008
    ds_read_b64_tr_b16 v[162:163], v18 offset:43264
    v_mfma_f32_32x32x16_bf16 v[116:131], v[68:71], v[140:143], v[116:131]
    ds_read_b64_tr_b16 v[164:165], v18 offset:47104
    ds_read_b64_tr_b16 v[166:167], v18 offset:47360
    buffer_load_dwordx4 v[68:71], v16, s[24:27], s53 offen offset:0 sc1
    s_waitcnt lgkmcnt(6)
    v_mfma_f32_32x32x16_bf16 v[84:99], v[144:147], v[72:75], v[84:99]
    ds_read_b64_tr_b16 v[132:133], v18 offset:39936
    ds_read_b64_tr_b16 v[134:135], v18 offset:40192
    v_mfma_f32_32x32x16_bf16 v[100:115], v[148:151], v[72:75], v[100:115]
    ds_read_b64_tr_b16 v[136:137], v18 offset:44032
    ds_read_b64_tr_b16 v[138:139], v18 offset:44288
    v_mfma_f32_32x32x16_bf16 v[116:131], v[72:75], v[152:155], v[116:131]
    ds_read_b64_tr_b16 v[140:141], v18 offset:48128
    ds_read_b64_tr_b16 v[142:143], v18 offset:48384
    buffer_load_dwordx4 v[72:75], v16, s[24:27], s53 offen offset:1024 sc1
    s_waitcnt lgkmcnt(6)
    v_mfma_f32_32x32x16_bf16 v[84:99], v[156:159], v[76:79], v[84:99]
    ds_read_b64_tr_b16 v[144:145], v19 offset:0
    ds_read_b64_tr_b16 v[146:147], v19 offset:256
    v_mfma_f32_32x32x16_bf16 v[100:115], v[160:163], v[76:79], v[100:115]
    ds_read_b64_tr_b16 v[148:149], v19 offset:4096
    ds_read_b64_tr_b16 v[150:151], v19 offset:4352
    v_mfma_f32_32x32x16_bf16 v[116:131], v[76:79], v[164:167], v[116:131]
    ds_read_b64_tr_b16 v[152:153], v19 offset:8192
    ds_read_b64_tr_b16 v[154:155], v19 offset:8448
    buffer_load_dwordx4 v[76:79], v16, s[24:27], s53 offen offset:2048 sc1
    s_waitcnt lgkmcnt(6)
    v_mfma_f32_32x32x16_bf16 v[84:99], v[132:135], v[80:83], v[84:99]
    ds_read_b64_tr_b16 v[156:157], v19 offset:1024
    ds_read_b64_tr_b16 v[158:159], v19 offset:1280
    v_mfma_f32_32x32x16_bf16 v[100:115], v[136:139], v[80:83], v[100:115]
    ds_read_b64_tr_b16 v[160:161], v19 offset:5120
    ds_read_b64_tr_b16 v[162:163], v19 offset:5376
    v_mfma_f32_32x32x16_bf16 v[116:131], v[80:83], v[140:143], v[116:131]
    ds_read_b64_tr_b16 v[164:165], v19 offset:9216
    ds_read_b64_tr_b16 v[166:167], v19 offset:9472
    s_mov_b32 s69, 0x8000
    s_waitcnt vmcnt(11)
    s_branch mega_ck_53_c
mega_ck_53:
    buffer_load_dwordx4 v[20:23], v16, s[24:27], s62 offen offset:0 sc1
    buffer_load_dwordx4 v[24:27], v16, s[24:27], s62 offen offset:1024 sc1
    buffer_load_dwordx4 v[28:31], v16, s[24:27], s62 offen offset:2048 sc1
    buffer_load_dwordx4 v[32:35], v16, s[24:27], s62 offen offset:3072 sc1
    s_waitcnt vmcnt(0)
mega_ck_53_c:
    v_max3_u32 v15, v20, v21, v22
    v_max3_u32 v15, v15, v23, v24
    v_max3_u32 v15, v15, v25, v26
    v_max3_u32 v15, v15, v27, v28
    v_max3_u32 v15, v15, v29, v30
    v_max3_u32 v15, v15, v31, v32
    v_max3_u32 v15, v15, v33, v34
    v_max_u32 v15, v15, v35
    v_cmp_eq_u32 vcc, -1, v15
    s_cmp_eq_u64 vcc, 0
    s_cbranch_scc1 mega_ck_53_d
    s_sub_u32 s69, s69, 1
    s_cbranch_scc1 mega_ck_53_d

    s_cmp_lg_u32 s69, 32744
    s_cbranch_scc1 mega_ck_53_ns

    v_or_b32 v16, 0x1000000, v16
mega_ck_53_ns:
    s_sleep 1
    s_branch mega_ck_53

mega_ck_53_d:
    buffer_load_dwordx4 v[80:83], v16, s[24:27], s53 offen offset:3072 sc1
    s_waitcnt lgkmcnt(6)
    v_mfma_f32_32x32x16_bf16 v[84:99], v[144:147], v[20:23], v[84:99]
    ds_read_b64_tr_b16 v[132:133], v19 offset:2048
    ds_read_b64_tr_b16 v[134:135], v19 offset:2304
    v_mfma_f32_32x32x16_bf16 v[100:115], v[148:151], v[20:23], v[100:115]
    ds_read_b64_tr_b16 v[136:137], v19 offset:6144
    ds_read_b64_tr_b16 v[138:139], v19 offset:6400
    v_mfma_f32_32x32x16_bf16 v[116:131], v[20:23], v[152:155], v[116:131]
    ds_read_b64_tr_b16 v[140:141], v19 offset:10240
    ds_read_b64_tr_b16 v[142:143], v19 offset:10496
    s_waitcnt lgkmcnt(6)
    v_mfma_f32_32x32x16_bf16 v[84:99], v[156:159], v[24:27], v[84:99]
    ds_read_b64_tr_b16 v[144:145], v19 offset:3072
    ds_read_b64_tr_b16 v[146:147], v19 offset:3328
    v_mfma_f32_32x32x16_bf16 v[100:115], v[160:163], v[24:27], v[100:115]
    ds_read_b64_tr_b16 v[148:149], v19 offset:7168
    ds_read_b64_tr_b16 v[150:151], v19 offset:7424
    v_mfma_f32_32x32x16_bf16 v[116:131], v[24:27], v[164:167], v[116:131]
    ds_read_b64_tr_b16 v[152:153], v19 offset:11264
    ds_read_b64_tr_b16 v[154:155], v19 offset:11520
    s_waitcnt lgkmcnt(6)
    v_mfma_f32_32x32x16_bf16 v[84:99], v[132:135], v[28:31], v[84:99]
    ds_read_b64_tr_b16 v[156:157], v19 offset:12288
    ds_read_b64_tr_b16 v[158:159], v19 offset:12544
    v_mfma_f32_32x32x16_bf16 v[100:115], v[136:139], v[28:31], v[100:115]
    ds_read_b64_tr_b16 v[160:161], v19 offset:16384
    ds_read_b64_tr_b16 v[162:163], v19 offset:16640
    v_mfma_f32_32x32x16_bf16 v[116:131], v[28:31], v[140:143], v[116:131]
    ds_read_b64_tr_b16 v[164:165], v19 offset:20480
    ds_read_b64_tr_b16 v[166:167], v19 offset:20736
    s_waitcnt lgkmcnt(6)
    v_mfma_f32_32x32x16_bf16 v[84:99], v[144:147], v[32:35], v[84:99]
    ds_read_b64_tr_b16 v[132:133], v19 offset:13312
    ds_read_b64_tr_b16 v[134:135], v19 offset:13568
    v_mfma_f32_32x32x16_bf16 v[100:115], v[148:151], v[32:35], v[100:115]
    ds_read_b64_tr_b16 v[136:137], v19 offset:17408
    ds_read_b64_tr_b16 v[138:139], v19 offset:17664
    v_mfma_f32_32x32x16_bf16 v[116:131], v[32:35], v[152:155], v[116:131]
    ds_read_b64_tr_b16 v[140:141], v19 offset:21504
    ds_read_b64_tr_b16 v[142:143], v19 offset:21760
    s_mov_b32 s69, 0x8000
    s_waitcnt vmcnt(8)
    s_branch mega_ck_54_c
mega_ck_54:
    buffer_load_dwordx4 v[36:39], v16, s[24:27], s63 offen offset:0 sc1
    buffer_load_dwordx4 v[40:43], v16, s[24:27], s63 offen offset:1024 sc1
    buffer_load_dwordx4 v[44:47], v16, s[24:27], s63 offen offset:2048 sc1
    buffer_load_dwordx4 v[48:51], v16, s[24:27], s63 offen offset:3072 sc1
    s_waitcnt vmcnt(0)
mega_ck_54_c:
    v_max3_u32 v15, v36, v37, v38
    v_max3_u32 v15, v15, v39, v40
    v_max3_u32 v15, v15, v41, v42
    v_max3_u32 v15, v15, v43, v44
    v_max3_u32 v15, v15, v45, v46
    v_max3_u32 v15, v15, v47, v48
    v_max3_u32 v15, v15, v49, v50
    v_max_u32 v15, v15, v51
    v_cmp_eq_u32 vcc, -1, v15
    s_cmp_eq_u64 vcc, 0
    s_cbranch_scc1 mega_ck_54_d
    s_sub_u32 s69, s69, 1
    s_cbranch_scc1 mega_ck_54_d

    s_cmp_lg_u32 s69, 32744
    s_cbranch_scc1 mega_ck_54_ns

    v_or_b32 v16, 0x1000000, v16
mega_ck_54_ns:
    s_sleep 1
    s_branch mega_ck_54

mega_ck_54_d:
    s_waitcnt lgkmcnt(6)
    v_mfma_f32_32x32x16_bf16 v[84:99], v[156:159], v[36:39], v[84:99]
    ds_read_b64_tr_b16 v[144:145], v19 offset:14336
    ds_read_b64_tr_b16 v[146:147], v19 offset:14592
    v_mfma_f32_32x32x16_bf16 v[100:115], v[160:163], v[36:39], v[100:115]
    ds_read_b64_tr_b16 v[148:149], v19 offset:18432
    ds_read_b64_tr_b16 v[150:151], v19 offset:18688
    v_mfma_f32_32x32x16_bf16 v[116:131], v[36:39], v[164:167], v[116:131]
    ds_read_b64_tr_b16 v[152:153], v19 offset:22528
    ds_read_b64_tr_b16 v[154:155], v19 offset:22784
    s_waitcnt lgkmcnt(6)
    v_mfma_f32_32x32x16_bf16 v[84:99], v[132:135], v[40:43], v[84:99]
    ds_read_b64_tr_b16 v[156:157], v19 offset:15360
    ds_read_b64_tr_b16 v[158:159], v19 offset:15616
    v_mfma_f32_32x32x16_bf16 v[100:115], v[136:139], v[40:43], v[100:115]
    ds_read_b64_tr_b16 v[160:161], v19 offset:19456
    ds_read_b64_tr_b16 v[162:163], v19 offset:19712
    v_mfma_f32_32x32x16_bf16 v[116:131], v[40:43], v[140:143], v[116:131]
    ds_read_b64_tr_b16 v[164:165], v19 offset:23552
    ds_read_b64_tr_b16 v[166:167], v19 offset:23808
    s_waitcnt lgkmcnt(6)
    v_mfma_f32_32x32x16_bf16 v[84:99], v[144:147], v[44:47], v[84:99]
    ds_read_b64_tr_b16 v[132:133], v19 offset:24576
    ds_read_b64_tr_b16 v[134:135], v19 offset:24832
    v_mfma_f32_32x32x16_bf16 v[100:115], v[148:151], v[44:47], v[100:115]
    ds_read_b64_tr_b16 v[136:137], v19 offset:28672
    ds_read_b64_tr_b16 v[138:139], v19 offset:28928
    v_mfma_f32_32x32x16_bf16 v[116:131], v[44:47], v[152:155], v[116:131]
    ds_read_b64_tr_b16 v[140:141], v19 offset:32768
    ds_read_b64_tr_b16 v[142:143], v19 offset:33024
    s_waitcnt lgkmcnt(6)
    v_mfma_f32_32x32x16_bf16 v[84:99], v[156:159], v[48:51], v[84:99]
    ds_read_b64_tr_b16 v[144:145], v19 offset:25600
    ds_read_b64_tr_b16 v[146:147], v19 offset:25856
    v_mfma_f32_32x32x16_bf16 v[100:115], v[160:163], v[48:51], v[100:115]
    ds_read_b64_tr_b16 v[148:149], v19 offset:29696
    ds_read_b64_tr_b16 v[150:151], v19 offset:29952
    v_mfma_f32_32x32x16_bf16 v[116:131], v[48:51], v[164:167], v[116:131]
    ds_read_b64_tr_b16 v[152:153], v19 offset:33792
    ds_read_b64_tr_b16 v[154:155], v19 offset:34048
    s_mov_b32 s69, 0x8000
    s_waitcnt vmcnt(4)
    s_branch mega_ck_55_c
mega_ck_55:
    buffer_load_dwordx4 v[52:55], v16, s[24:27], s52 offen offset:0 sc1
    buffer_load_dwordx4 v[56:59], v16, s[24:27], s52 offen offset:1024 sc1
    buffer_load_dwordx4 v[60:63], v16, s[24:27], s52 offen offset:2048 sc1
    buffer_load_dwordx4 v[64:67], v16, s[24:27], s52 offen offset:3072 sc1
    s_waitcnt vmcnt(0)
mega_ck_55_c:
    v_max3_u32 v15, v52, v53, v54
    v_max3_u32 v15, v15, v55, v56
    v_max3_u32 v15, v15, v57, v58
    v_max3_u32 v15, v15, v59, v60
    v_max3_u32 v15, v15, v61, v62
    v_max3_u32 v15, v15, v63, v64
    v_max3_u32 v15, v15, v65, v66
    v_max_u32 v15, v15, v67
    v_cmp_eq_u32 vcc, -1, v15
    s_cmp_eq_u64 vcc, 0
    s_cbranch_scc1 mega_ck_55_d
    s_sub_u32 s69, s69, 1
    s_cbranch_scc1 mega_ck_55_d

    s_cmp_lg_u32 s69, 32744
    s_cbranch_scc1 mega_ck_55_ns

    v_or_b32 v16, 0x1000000, v16
mega_ck_55_ns:
    s_sleep 1
    s_branch mega_ck_55

mega_ck_55_d:
    s_waitcnt lgkmcnt(6)
    v_mfma_f32_32x32x16_bf16 v[84:99], v[132:135], v[52:55], v[84:99]
    ds_read_b64_tr_b16 v[156:157], v19 offset:26624
    ds_read_b64_tr_b16 v[158:159], v19 offset:26880
    v_mfma_f32_32x32x16_bf16 v[100:115], v[136:139], v[52:55], v[100:115]
    ds_read_b64_tr_b16 v[160:161], v19 offset:30720
    ds_read_b64_tr_b16 v[162:163], v19 offset:30976
    v_mfma_f32_32x32x16_bf16 v[116:131], v[52:55], v[140:143], v[116:131]
    ds_read_b64_tr_b16 v[164:165], v19 offset:34816
    ds_read_b64_tr_b16 v[166:167], v19 offset:35072
    s_waitcnt lgkmcnt(6)
    v_mfma_f32_32x32x16_bf16 v[84:99], v[144:147], v[56:59], v[84:99]
    ds_read_b64_tr_b16 v[132:133], v19 offset:27648
    ds_read_b64_tr_b16 v[134:135], v19 offset:27904
    v_mfma_f32_32x32x16_bf16 v[100:115], v[148:151], v[56:59], v[100:115]
    ds_read_b64_tr_b16 v[136:137], v19 offset:31744
    ds_read_b64_tr_b16 v[138:139], v19 offset:32000
    v_mfma_f32_32x32x16_bf16 v[116:131], v[56:59], v[152:155], v[116:131]
    ds_read_b64_tr_b16 v[140:141], v19 offset:35840
    ds_read_b64_tr_b16 v[142:143], v19 offset:36096
    s_waitcnt lgkmcnt(6)
    v_mfma_f32_32x32x16_bf16 v[84:99], v[156:159], v[60:63], v[84:99]
    ds_read_b64_tr_b16 v[144:145], v19 offset:36864
    ds_read_b64_tr_b16 v[146:147], v19 offset:37120
    v_mfma_f32_32x32x16_bf16 v[100:115], v[160:163], v[60:63], v[100:115]
    ds_read_b64_tr_b16 v[148:149], v19 offset:40960
    ds_read_b64_tr_b16 v[150:151], v19 offset:41216
    v_mfma_f32_32x32x16_bf16 v[116:131], v[60:63], v[164:167], v[116:131]
    ds_read_b64_tr_b16 v[152:153], v19 offset:45056
    ds_read_b64_tr_b16 v[154:155], v19 offset:45312
    s_waitcnt lgkmcnt(6)
    v_mfma_f32_32x32x16_bf16 v[84:99], v[132:135], v[64:67], v[84:99]
    ds_read_b64_tr_b16 v[156:157], v19 offset:37888
    ds_read_b64_tr_b16 v[158:159], v19 offset:38144
    v_mfma_f32_32x32x16_bf16 v[100:115], v[136:139], v[64:67], v[100:115]
    ds_read_b64_tr_b16 v[160:161], v19 offset:41984
    ds_read_b64_tr_b16 v[162:163], v19 offset:42240
    v_mfma_f32_32x32x16_bf16 v[116:131], v[64:67], v[140:143], v[116:131]
    ds_read_b64_tr_b16 v[164:165], v19 offset:46080
    ds_read_b64_tr_b16 v[166:167], v19 offset:46336
    s_mov_b32 s69, 0x8000
    s_waitcnt vmcnt(0)
    s_branch mega_ck_56_c
mega_ck_56:
    buffer_load_dwordx4 v[68:71], v16, s[24:27], s53 offen offset:0 sc1
    buffer_load_dwordx4 v[72:75], v16, s[24:27], s53 offen offset:1024 sc1
    buffer_load_dwordx4 v[76:79], v16, s[24:27], s53 offen offset:2048 sc1
    buffer_load_dwordx4 v[80:83], v16, s[24:27], s53 offen offset:3072 sc1
    s_waitcnt vmcnt(0)
mega_ck_56_c:
    v_max3_u32 v15, v68, v69, v70
    v_max3_u32 v15, v15, v71, v72
    v_max3_u32 v15, v15, v73, v74
    v_max3_u32 v15, v15, v75, v76
    v_max3_u32 v15, v15, v77, v78
    v_max3_u32 v15, v15, v79, v80
    v_max3_u32 v15, v15, v81, v82
    v_max_u32 v15, v15, v83
    v_cmp_eq_u32 vcc, -1, v15
    s_cmp_eq_u64 vcc, 0
    s_cbranch_scc1 mega_ck_56_d
    s_sub_u32 s69, s69, 1
    s_cbranch_scc1 mega_ck_56_d

    s_cmp_lg_u32 s69, 32744
    s_cbranch_scc1 mega_ck_56_ns

    v_or_b32 v16, 0x1000000, v16
mega_ck_56_ns:
    s_sleep 1
    s_branch mega_ck_56

mega_ck_56_d:
    s_waitcnt lgkmcnt(6)
    v_mfma_f32_32x32x16_bf16 v[84:99], v[144:147], v[68:71], v[84:99]
    ds_read_b64_tr_b16 v[132:133], v19 offset:38912
    ds_read_b64_tr_b16 v[134:135], v19 offset:39168
    v_mfma_f32_32x32x16_bf16 v[100:115], v[148:151], v[68:71], v[100:115]
    ds_read_b64_tr_b16 v[136:137], v19 offset:43008
    ds_read_b64_tr_b16 v[138:139], v19 offset:43264
    v_mfma_f32_32x32x16_bf16 v[116:131], v[68:71], v[152:155], v[116:131]
    ds_read_b64_tr_b16 v[140:141], v19 offset:47104
    ds_read_b64_tr_b16 v[142:143], v19 offset:47360
    s_waitcnt lgkmcnt(6)
    v_mfma_f32_32x32x16_bf16 v[84:99], v[156:159], v[72:75], v[84:99]
    ds_read_b64_tr_b16 v[144:145], v19 offset:39936
    ds_read_b64_tr_b16 v[146:147], v19 offset:40192
    v_mfma_f32_32x32x16_bf16 v[100:115], v[160:163], v[72:75], v[100:115]
    ds_read_b64_tr_b16 v[148:149], v19 offset:44032
    ds_read_b64_tr_b16 v[150:151], v19 offset:44288
    v_mfma_f32_32x32x16_bf16 v[116:131], v[72:75], v[164:167], v[116:131]
    ds_read_b64_tr_b16 v[152:153], v19 offset:48128
    ds_read_b64_tr_b16 v[154:155], v19 offset:48384
    s_waitcnt lgkmcnt(6)
    s_barrier
    v_mfma_f32_32x32x16_bf16 v[84:99], v[132:135], v[76:79], v[84:99]
    v_mfma_f32_32x32x16_bf16 v[100:115], v[136:139], v[76:79], v[100:115]
    v_mfma_f32_32x32x16_bf16 v[116:131], v[76:79], v[140:143], v[116:131]
    ds_read_b32 v16, v12
    ds_read_b32 v17, v12 offset:128
    ds_read_b32 v14, v5 offset:2304
    ds_read_b128 v[20:23], v13 offset:2048
    ds_read_b128 v[24:27], v13 offset:2080
    ds_read_b128 v[28:31], v13 offset:2112
    ds_read_b128 v[32:35], v13 offset:2144
    s_waitcnt lgkmcnt(0)
    v_mfma_f32_32x32x16_bf16 v[84:99], v[144:147], v[80:83], v[84:99]
    v_mfma_f32_32x32x16_bf16 v[100:115], v[148:151], v[80:83], v[100:115]
    v_mfma_f32_32x32x16_bf16 v[116:131], v[80:83], v[152:155], v[116:131]
    ds_read_b128 v[36:39], v13 offset:2176
    ds_read_b128 v[52:55], v11 offset:0
    ds_read_b128 v[68:71], v11 offset:128
    ds_read_b128 v[40:43], v13 offset:2208
    ds_read_b128 v[56:59], v11 offset:32
    ds_read_b128 v[72:75], v11 offset:160
    ds_read_b128 v[44:47], v13 offset:2240
    ds_read_b128 v[60:63], v11 offset:64
    ds_read_b128 v[76:79], v11 offset:192
    ds_read_b128 v[48:51], v13 offset:2272
    ds_read_b128 v[64:67], v11 offset:96
    ds_read_b128 v[80:83], v11 offset:224
    s_mov_b32 s56, 0x3eb8aa3b
    v_mul_f32 v6, s56, v16
    v_mul_f32 v8, s56, v17
    v_mov_b32 v7, v6
    v_mov_b32 v9, v8
    v_mov_b32 v18, v17
    v_mov_b32 v19, v17
    v_mov_b32 v17, v16
    v_mov_b32 v15, v14

    s_waitcnt lgkmcnt(0)
    s_barrier
    v_pk_mul_f32 v[100:101], v[100:101], v[16:17]
    v_pk_mul_f32 v[102:103], v[102:103], v[16:17]
    v_pk_mul_f32 v[104:105], v[104:105], v[16:17]
    v_pk_mul_f32 v[106:107], v[106:107], v[16:17]
    v_pk_mul_f32 v[108:109], v[108:109], v[16:17]
    v_pk_mul_f32 v[110:111], v[110:111], v[16:17]
    v_pk_mul_f32 v[112:113], v[112:113], v[16:17]
    v_pk_mul_f32 v[114:115], v[114:115], v[16:17]
    v_pk_fma_f32 v[100:101], v[36:37], v[18:19], v[100:101]
    v_pk_fma_f32 v[102:103], v[38:39], v[18:19], v[102:103]
    v_pk_fma_f32 v[104:105], v[40:41], v[18:19], v[104:105]
    v_pk_fma_f32 v[106:107], v[42:43], v[18:19], v[106:107]
    v_pk_fma_f32 v[108:109], v[44:45], v[18:19], v[108:109]
    v_pk_fma_f32 v[110:111], v[46:47], v[18:19], v[110:111]
    v_pk_fma_f32 v[112:113], v[48:49], v[18:19], v[112:113]
    v_pk_fma_f32 v[114:115], v[50:51], v[18:19], v[114:115]
    v_cvt_pk_bf16_f32 v140, v100, v101
    v_cvt_pk_bf16_f32 v141, v102, v103
    v_cvt_pk_bf16_f32 v142, v104, v105
    v_cvt_pk_bf16_f32 v143, v106, v107
    v_cvt_pk_bf16_f32 v144, v108, v109
    v_cvt_pk_bf16_f32 v145, v110, v111
    v_cvt_pk_bf16_f32 v146, v112, v113
    v_cvt_pk_bf16_f32 v147, v114, v115
    v_min_u32 v140, s67, v140
    v_min_u32 v141, s67, v141
    v_min_u32 v142, s67, v142
    v_min_u32 v143, s67, v143
    v_min_u32 v144, s67, v144
    v_min_u32 v145, s67, v145
    v_min_u32 v146, s67, v146
    v_min_u32 v147, s67, v147
    s_add_u32 s58, s57, 0x200000
    buffer_store_dwordx4 v[140:143], v3, s[24:27], s58 offen sc1
    s_add_u32 s58, s57, 0x210000
    buffer_store_dwordx4 v[144:147], v3, s[24:27], s58 offen sc1
    v_pk_mul_f32 v[116:117], v[116:117], v[52:53]
    v_pk_mul_f32 v[118:119], v[118:119], v[54:55]
    v_pk_mul_f32 v[120:121], v[120:121], v[56:57]
    v_pk_mul_f32 v[122:123], v[122:123], v[58:59]
    v_pk_mul_f32 v[124:125], v[124:125], v[60:61]
    v_pk_mul_f32 v[126:127], v[126:127], v[62:63]
    v_pk_mul_f32 v[128:129], v[128:129], v[64:65]
    v_pk_mul_f32 v[130:131], v[130:131], v[66:67]
    v_pk_fma_f32 v[116:117], v[68:69], v[14:15], v[116:117]
    v_pk_fma_f32 v[118:119], v[70:71], v[14:15], v[118:119]
    v_pk_fma_f32 v[120:121], v[72:73], v[14:15], v[120:121]
    v_pk_fma_f32 v[122:123], v[74:75], v[14:15], v[122:123]
    v_pk_fma_f32 v[124:125], v[76:77], v[14:15], v[124:125]
    v_pk_fma_f32 v[126:127], v[78:79], v[14:15], v[126:127]
    v_pk_fma_f32 v[128:129], v[80:81], v[14:15], v[128:129]
    v_pk_fma_f32 v[130:131], v[82:83], v[14:15], v[130:131]
    v_cvt_pk_bf16_f32 v148, v116, v117
    v_cvt_pk_bf16_f32 v149, v118, v119
    v_cvt_pk_bf16_f32 v150, v120, v121
    v_cvt_pk_bf16_f32 v151, v122, v123
    v_cvt_pk_bf16_f32 v152, v124, v125
    v_cvt_pk_bf16_f32 v153, v126, v127
    v_cvt_pk_bf16_f32 v154, v128, v129
    v_cvt_pk_bf16_f32 v155, v130, v131
    v_min_u32 v148, s67, v148
    v_min_u32 v149, s67, v149
    v_min_u32 v150, s67, v150
    v_min_u32 v151, s67, v151
    v_min_u32 v152, s67, v152
    v_min_u32 v153, s67, v153
    v_min_u32 v154, s67, v154
    v_min_u32 v155, s67, v155
    s_add_u32 s58, s57, 0x400000
    buffer_store_dwordx4 v[148:151], v10, s[24:27], s58 offen sc1
    buffer_store_dwordx4 v[152:155], v10, s[24:27], s58 offen offset:512 sc1

    v_pk_mul_f32 v[84:85], v[84:85], v[6:7]
    v_pk_mul_f32 v[86:87], v[86:87], v[6:7]
    v_pk_mul_f32 v[88:89], v[88:89], v[6:7]
    v_pk_mul_f32 v[90:91], v[90:91], v[6:7]
    v_pk_mul_f32 v[92:93], v[92:93], v[6:7]
    v_pk_mul_f32 v[94:95], v[94:95], v[6:7]
    v_pk_mul_f32 v[96:97], v[96:97], v[6:7]
    v_pk_mul_f32 v[98:99], v[98:99], v[6:7]
    v_pk_fma_f32 v[84:85], v[20:21], v[8:9], v[84:85]
    v_pk_fma_f32 v[86:87], v[22:23], v[8:9], v[86:87]
    v_pk_fma_f32 v[88:89], v[24:25], v[8:9], v[88:89]
    v_pk_fma_f32 v[90:91], v[26:27], v[8:9], v[90:91]
    v_pk_fma_f32 v[92:93], v[28:29], v[8:9], v[92:93]
    v_pk_fma_f32 v[94:95], v[30:31], v[8:9], v[94:95]
    v_pk_fma_f32 v[96:97], v[32:33], v[8:9], v[96:97]
    v_pk_fma_f32 v[98:99], v[34:35], v[8:9], v[98:99]
    v_cvt_pk_bf16_f32 v132, v84, v85
    v_cvt_pk_bf16_f32 v133, v86, v87
    v_cvt_pk_bf16_f32 v134, v88, v89
    v_cvt_pk_bf16_f32 v135, v90, v91
    v_cvt_pk_bf16_f32 v136, v92, v93
    v_cvt_pk_bf16_f32 v137, v94, v95
    v_cvt_pk_bf16_f32 v138, v96, v97
    v_cvt_pk_bf16_f32 v139, v98, v99
    v_min_u32 v132, s67, v132
    v_min_u32 v133, s67, v133
    v_min_u32 v134, s67, v134
    v_min_u32 v135, s67, v135
    v_min_u32 v136, s67, v136
    v_min_u32 v137, s67, v137
    v_min_u32 v138, s67, v138
    v_min_u32 v139, s67, v139
    s_add_u32 s58, s57, 0x0
    buffer_store_dwordx4 v[132:135], v3, s[24:27], s58 offen sc1
    s_add_u32 s58, s57, 0x10000
    buffer_store_dwordx4 v[136:139], v3, s[24:27], s58 offen sc1
mega_qend:
    s_mov_b32 s3, 1
    s_branch mega_layer

mega_done:
    s_endpgm
mega_fb:
    s_add_u32 s52, s48, 0x200000
    v_mov_b32 v14, 0xff800000
    s_mov_b32 s59, 64

mega_fbl:
    buffer_load_dwordx4 v[88:91], v3, s[24:27], s52 offen sc1
    s_add_u32 s52, s52, 1024
    s_waitcnt vmcnt(0)
    v_mfma_f32_32x32x16_bf16 v[16:31], v[88:91], v[4:7], 0
    s_nop 15

    v_max3_f32 v14, v14, v16, v17
    v_max3_f32 v14, v14, v18, v19
    v_max3_f32 v14, v14, v20, v21
    v_max3_f32 v14, v14, v22, v23
    v_max3_f32 v14, v14, v24, v25
    v_max3_f32 v14, v14, v26, v27
    v_max3_f32 v14, v14, v28, v29
    v_max3_f32 v14, v14, v30, v31
    s_sub_u32 s59, s59, 1
    s_cmp_lg_u32 s59, 0
    s_cbranch_scc1 mega_fbl
    v_mov_b32 v15, v14
    s_nop 1
    v_permlane32_swap_b32 v14, v15
    s_nop 1
    v_max_f32 v14, v14, v15
    v_sub_f32 v14, 0, v14

    v_mov_b32 v64, v14
    v_mov_b32 v48, 0
    v_mov_b32 v65, v14
    v_mov_b32 v49, 0
    v_mov_b32 v66, v14
    v_mov_b32 v50, 0
    v_mov_b32 v67, v14
    v_mov_b32 v51, 0
    v_mov_b32 v68, v14
    v_mov_b32 v52, 0
    v_mov_b32 v69, v14
    v_mov_b32 v53, 0
    v_mov_b32 v70, v14
    v_mov_b32 v54, 0
    v_mov_b32 v71, v14
    v_mov_b32 v55, 0
    v_mov_b32 v72, v14
    v_mov_b32 v56, 0
    v_mov_b32 v73, v14
    v_mov_b32 v57, 0
    v_mov_b32 v74, v14
    v_mov_b32 v58, 0
    v_mov_b32 v75, v14
    v_mov_b32 v59, 0
    v_mov_b32 v76, v14
    v_mov_b32 v60, 0
    v_mov_b32 v77, v14
    v_mov_b32 v61, 0
    v_mov_b32 v78, v14
    v_mov_b32 v62, 0
    v_mov_b32 v79, v14
    v_mov_b32 v63, 0
    v_and_b32 v13, 15, v1
    v_lshlrev_b32 v13, 4, v13
    v_lshrrev_b32 v14, 5, v1
    v_lshl_add_u32 v13, v14, 8, v13
    s_add_u32 s52, s48, 0x200000
    s_add_u32 s53, s48, 0x400000
    s_mov_b32 s59, 64

mega_fbm:
    buffer_load_dwordx4 v[88:91], v3, s[24:27], s52 offen sc1
    s_mov_b64 exec, s[56:57]
    buffer_load_dwordx4 v[96:99], v13, s[24:27], s53 offen sc1
    buffer_load_dwordx4 v[100:103], v13, s[24:27], s53 offen offset:512 sc1
    s_mov_b64 exec, -1
    s_add_u32 s52, s52, 1024
    s_add_u32 s53, s53, 1024
    s_waitcnt vmcnt(0)
    v_mfma_f32_32x32x16_bf16 v[16:31], v[88:91], v[4:7], v[64:79]
    s_nop 15

    v_exp_f32 v16, v16
    v_exp_f32 v17, v17
    v_exp_f32 v18, v18
    v_exp_f32 v19, v19
    v_exp_f32 v20, v20
    v_exp_f32 v21, v21
    v_exp_f32 v22, v22
    v_exp_f32 v23, v23
    v_exp_f32 v24, v24
    v_exp_f32 v25, v25
    v_exp_f32 v26, v26
    v_exp_f32 v27, v27
    v_exp_f32 v28, v28
    v_exp_f32 v29, v29
    v_exp_f32 v30, v30
    v_exp_f32 v31, v31
    s_nop 0
    v_cvt_pk_bf16_f32 v80, v16, v17
    v_cvt_pk_bf16_f32 v81, v18, v19
    v_cvt_pk_bf16_f32 v82, v20, v21
    v_cvt_pk_bf16_f32 v83, v22, v23
    v_cvt_pk_bf16_f32 v84, v24, v25
    v_cvt_pk_bf16_f32 v85, v26, v27
    v_cvt_pk_bf16_f32 v86, v28, v29
    v_cvt_pk_bf16_f32 v87, v30, v31
    s_nop 1
    v_mfma_f32_32x32x16_bf16 v[48:63], v[96:99], v[80:83], v[48:63]
    v_mfma_f32_32x32x16_bf16 v[48:63], v[100:103], v[84:87], v[48:63]
    s_sub_u32 s59, s59, 1
    s_cmp_lg_u32 s59, 0
    s_cbranch_scc1 mega_fbm
    s_nop 15
    s_branch mega_fin

all_code_end:
.section .rodata,"a"
.p2align 6
.amdhsa_kernel qkv1_kernel
  .amdhsa_next_free_vgpr 212
  .amdhsa_next_free_sgpr 96
  .amdhsa_accum_offset 212
  .amdhsa_group_segment_fixed_size 0
  .amdhsa_kernarg_size 96
  .amdhsa_user_sgpr_count 2
  .amdhsa_user_sgpr_kernarg_segment_ptr 1
  .amdhsa_system_sgpr_workgroup_id_x 1
.end_amdhsa_kernel
.p2align 6
.amdhsa_kernel mega_kernel
  .amdhsa_next_free_vgpr 168
  .amdhsa_next_free_sgpr 96
  .amdhsa_accum_offset 168
  .amdhsa_group_segment_fixed_size 0
  .amdhsa_kernarg_size 96
  .amdhsa_user_sgpr_count 2
  .amdhsa_user_sgpr_kernarg_segment_ptr 1
  .amdhsa_system_sgpr_workgroup_id_x 1
.end_amdhsa_kernel
```
